```python
import torch

def _softmax(x, axis=-1):
    return torch.softmax(x, dim=axis)
def _gelu(x):
    return torch.nn.functional.gelu(x, approximate="tanh")
def _silu(x):
    return torch.nn.functional.silu(x)
def _sigmoid(x):
    return torch.sigmoid(x)
def _layernorm(x, axis=-1, eps=1e-5):
    m = x.mean(dim=axis, keepdim=True)
    v = x.var(dim=axis, keepdim=True, unbiased=False)
    return (x - m) / torch.sqrt(v + eps)
def _scatter_add(tgt, idx, src, axis=0):
    return tgt.clone().index_add_(axis, idx, src)
def _segment_sum(src, seg, n):
    out = torch.zeros((n,) + src.shape[1:], dtype=src.dtype)
    return out.index_add_(0, seg, src)
def _pad(x, pw):
    flat = tuple(v for pair in reversed(pw) for v in pair)
    return torch.nn.functional.pad(x, flat)

kernel_name = 'standalone__mixer_s_mlp__sampling'

def setup_inputs():

    _w = (lambda a: (lambda t: t.to(torch.bfloat16) if t.is_floating_point() else t)(torch.as_tensor(a)))
    B, S, D, F = 32, 32, 512, 1792
    return {
        "x":  _w((lambda *s: torch.randn(*s, dtype=torch.bfloat16) * 0.4)(B, S, D)),
        "w1": _w((lambda *s: torch.randn(*s, dtype=torch.bfloat16) * 3.2)(D, D) * (D ** -0.5)),
        "w2": _w((lambda *s: torch.randn(*s, dtype=torch.bfloat16) * 3.2)(D, D) * (D ** -0.5)),
        "w3": _w((lambda *s: torch.randn(*s, dtype=torch.bfloat16) * 3.2)(D, F) * (D ** -0.5)),
        "w4": _w((lambda *s: torch.randn(*s, dtype=torch.bfloat16) * 0.8)(F, D) * (F ** -0.5)),
    }

def reference(x, w1, w2, w3, w4):
    B, S, D = x.shape
    h = _gelu(_layernorm(x, axis=-1) @ w1)
    c = D // 4
    g0 = _pad(h[:, :, 0*c:1*c], ((0, 0), (1, 0), (0, 0)))[:, :S, :]
    g1 = _pad(h[:, :, 1*c:2*c], ((0, 0), (0, 1), (0, 0)))[:, 1:, :]
    g2 = _pad(h[:, :, 2*c:3*c], ((0, 0), (2, 0), (0, 0)))[:, :S, :]
    g3 = _pad(h[:, :, 3*c:   ], ((0, 0), (0, 2), (0, 0)))[:, 2:, :]
    hs = torch.concatenate([g0, g1, g2, g3], axis=-1) @ w2
    x1 = x + hs
    h2 = _gelu(_layernorm(x1, axis=-1) @ w3) @ w4
    return x1 + h2
```

```asm
; @launch grid=(256,1,1) block=(256,1,1) lds=163840
.amdgcn_target "amdgcn-amd-amdhsa--gfx950"
.text
.globl standalone__mixer_s_mlp__sampling_kernel
.p2align 8
.type standalone__mixer_s_mlp__sampling_kernel,@function
standalone__mixer_s_mlp__sampling_kernel:
  s_cmp_ge_u32 s2, 256
  s_cbranch_scc1 L_end
  s_load_dwordx16 s[48:63], s[0:1], 0
  v_lshrrev_b32 v16, 6, v0
  v_and_b32 v0, 63, v0
  s_lshr_b32 s5, s2, 3
  v_readfirstlane_b32 s11, v16
  s_and_b32 s6, s5, 7
  s_and_b32 s3, s2, 7
  s_lshl_b32 s7, s3, 2
  s_lshr_b32 s4, s5, 3
  s_add_u32 s7, s7, s4
  v_lshrrev_b32 v9, 4, v0
  v_and_b32 v10, 15, v0
  v_lshrrev_b32 v16, 3, v0
  v_lshlrev_b32 v16, 10, v16
  v_and_b32 v17, 7, v0
  s_and_b32 s3, s11, 1
  s_lshl_b32 s3, s3, 2
  v_xor_b32 v18, v17, v9
  v_xor_b32 v18, s3, v18
  v_lshl_add_u32 v18, v18, 4, v16
  s_lshl_b32 s3, s7, 15
  s_lshl_b32 s4, s11, 13
  s_add_u32 s73, s3, s4
  v_add_u32 v8, s73, v18
  v_and_b32 v18, 1, v9
  v_lshlrev_b32 v18, 1, v18
  v_xor_b32 v18, v17, v18
  v_lshl_add_u32 v18, v18, 4, v16
  s_lshl_b32 s3, s6, 7
  s_lshl_b32 s4, s11, 15
  s_add_u32 s4, s4, s3
  s_lshr_b32 s3, s5, 3
  s_lshl_b32 s3, s3, 17
  s_add_u32 s4, s4, s3
  v_add_u32 v6, s4, v18
  v_xor_b32 v7, 64, v6
  s_mov_b32 s18, 1048576
  s_mov_b32 s19, 0x20000
  s_mov_b32 s22, 524288
  s_mov_b32 s23, 0x20000
  s_mov_b32 s42, 8388608
  s_mov_b32 s43, 0x20000
  s_mov_b32 s26, 524288
  s_mov_b32 s27, 0x20000
  s_mov_b32 s34, 1835008
  s_mov_b32 s35, 0x20000
  s_mov_b32 s38, 1835008
  s_mov_b32 s39, 0x20000
  s_mov_b32 s46, 1048576
  s_mov_b32 s47, 0x20000
  s_lshr_b32 s10, s7, 1
  s_and_b32 s8, s5, 15
  s_and_b32 s9, s7, 0xfe
  s_cmp_gt_u32 s8, 3
  s_cselect_b32 s3, 1, 0
  s_sub_u32 s76, s8, s3
  s_cmp_gt_u32 s8, 11
  s_cselect_b32 s3, 1, 0
  s_sub_u32 s76, s76, s3
  s_cmp_eq_u32 s6, 3
  s_cselect_b32 s77, 1, 0
  s_getpc_b64 s[70:71]
L_pc0:
  s_lshl_b32 s15, s5, 2
  s_add_u32 s15, s15, s11
  s_lshl_b32 s15, s15, 8
  v_lshl_add_u32 v24, v0, 7, s15
  s_mov_b32 s67, L_code_end-L_pc0
  v_cmp_gt_u32 vcc, 2, v0
  v_cmp_gt_u32 s[28:29], s67, v24
  s_nop 1
  s_and_b64 vcc, vcc, s[28:29]
  s_and_saveexec_b64 s[28:29], vcc
  s_cbranch_execz L_nopf
  global_load_dword v15, v24, s[70:71]
L_nopf:
  s_mov_b64 exec, s[28:29]
  s_waitcnt lgkmcnt(0)
  s_mov_b32 s16, s48
  s_mov_b32 s17, s49
  s_mov_b32 s20, s50
  s_mov_b32 s21, s51
  s_lshl_b32 s3, s11, 13
  s_add_u32 m0, s3, 0
  s_nop 0
  buffer_load_dwordx4 v8, s[16:19], 0 offen lds
  s_add_u32 m0, s3, 896
  s_nop 0
  buffer_load_dwordx4 v8, s[16:19], 0 offen offset:128 lds
  s_add_u32 m0, s3, 1792
  s_nop 0
  buffer_load_dwordx4 v8, s[16:19], 0 offen offset:256 lds
  s_add_u32 m0, s3, 2688
  s_nop 0
  buffer_load_dwordx4 v8, s[16:19], 0 offen offset:384 lds
  s_add_u32 m0, s3, 3584
  s_nop 0
  buffer_load_dwordx4 v8, s[16:19], 0 offen offset:512 lds
  s_add_u32 m0, s3, 4480
  s_nop 0
  buffer_load_dwordx4 v8, s[16:19], 0 offen offset:640 lds
  s_add_u32 m0, s3, 5376
  s_nop 0
  buffer_load_dwordx4 v8, s[16:19], 0 offen offset:768 lds
  s_add_u32 m0, s3, 6272
  s_nop 0
  buffer_load_dwordx4 v8, s[16:19], 0 offen offset:896 lds
  s_mov_b32 s40, s62
  s_mov_b32 s41, s63
  s_mov_b32 s24, s52
  s_mov_b32 s25, s53
  s_mov_b32 s32, s54
  s_mov_b32 s33, s55
  s_mov_b32 s36, s56
  s_mov_b32 s37, s57
  s_mov_b32 s44, s58
  s_mov_b32 s45, s59
  s_lshl_b32 s48, s11, 13
  s_lshl_b32 s49, s11, 14
  s_lshl_b32 s50, s11, 12
  s_mov_b32 s51, 7168
  s_mov_b32 s52, 14336
  s_mov_b32 s53, 21504
  s_add_u32 m0, s50, 32768
  s_nop 0
  buffer_load_dwordx4 v6, s[20:23], 0 offen lds
  buffer_load_dwordx4 v7, s[20:23], s51 offen offset:1024 lds
  buffer_load_dwordx4 v6, s[20:23], s52 offen offset:2048 lds
  buffer_load_dwordx4 v7, s[20:23], s53 offen offset:3072 lds
  s_lshl_b32 s3, s10, 7
  s_add_u32 s3, s3, 7356416
  v_mov_b32 v127, s3
  buffer_load_dword v127, v127, s[40:43], 0 offen sc1
  v_lshlrev_b32 v3, 4, v0
  v_lshrrev_b32 v1, 5, v0
  v_and_b32 v2, 31, v0
  s_lshl_b32 s3, s7, 15
  s_lshl_b32 s4, s6, 12
  s_add_u32 s3, s3, s4
  s_lshl_b32 s4, s11, 10
  s_add_u32 s72, s3, s4
  v_and_b32 v16, 1, v9
  v_lshlrev_b32 v16, 9, v16
  v_lshl_add_u32 v16, v10, 4, v16
  v_lshrrev_b32 v17, 1, v9
  v_lshl_add_u32 v16, v17, 3, v16
  v_add_u32 v30, s72, v16
  v_and_b32 v70, 7, v0
  v_lshl_add_u32 v70, v70, 7, s72
  v_lshrrev_b32 v25, 3, v0
  v_lshl_add_u32 v70, v25, 20, v70
  s_lshr_b32 s3, s72, 2
  s_add_u32 s3, s3, 6289408
  v_lshl_add_u32 v25, v0, 7, s3
  v_cmp_gt_u32 vcc, 16, v0
  s_lshl_b32 s3, s7, 7
  s_add_u32 s3, s3, 7192576
  v_cndmask_b32 v70, v25, v70, vcc
  v_lshl_add_u32 v25, v0, 13, s3
  v_cmp_gt_u32 vcc, 18, v0
  s_lshl_b32 s3, s10, 8
  s_add_u32 s3, s3, 7349760
  v_cndmask_b32 v70, v25, v70, vcc
  v_lshl_add_u32 v25, v0, 7, s3
  v_cmp_gt_u32 vcc, 20, v0
  v_mov_b32 v26, 0x80000000
  s_nop 0
  v_cndmask_b32 v70, v25, v70, vcc
  v_cmp_gt_u32 vcc, 22, v0
  s_nop 1
  v_cndmask_b32 v70, v26, v70, vcc
  s_lshl_b32 s3, s7, 15
  s_lshl_b32 s4, s6, 7
  s_add_u32 s3, s3, s4
  s_lshl_b32 s4, s11, 5
  s_add_u32 s15, s3, s4
  v_lshlrev_b32 v16, 10, v10
  v_lshl_add_u32 v16, v9, 3, v16
  v_add_u32 v16, s15, v16
  s_mov_b32 s3, 16384
  buffer_load_dwordx2 v[116:117], v16, s[16:19], 0 offen
  buffer_load_dwordx2 v[118:119], v16, s[16:19], s3 offen
  v_lshlrev_b32 v16, 10, v2
  v_lshl_add_u32 v16, v1, 3, v16
  v_add_u32 v31, s15, v16
  s_mov_b32 s66, 4096
  s_mov_b32 s54, 13312
  s_mov_b32 s55, 26624
  s_mov_b32 s56, 39936
  s_lshr_b32 s60, s5, 3
  s_and_b32 s3, s2, 7
  s_and_b32 s61, s3, 3
  s_add_u32 s81, s3, s60
  s_and_b32 s81, s81, 3
  s_add_u32 s57, s3, s6
  s_cmp_ge_u32 s57, 7
  s_cselect_b32 s4, 7, 0
  s_sub_u32 s57, s57, s4
  s_cmp_ge_u32 s57, 7
  s_cselect_b32 s4, 7, 0
  s_sub_u32 s57, s57, s4
  s_lshl_b32 s79, s2, 2
  s_add_u32 s79, s79, s11
  s_lshl_b32 s3, s7, 7
  s_lshl_b32 s4, s6, 4
  s_add_u32 s3, s3, s4
  s_lshl_b32 s4, s11, 2
  s_add_u32 s75, s3, s4
  s_lshl_b32 s3, s10, 7
  s_add_u32 s78, s3, 7360512
  s_lshl_b32 s3, s9, 15
  s_add_u32 s74, s3, s48
  v_lshrrev_b32 v16, 3, v0
  v_lshlrev_b32 v16, 10, v16
  v_and_b32 v17, 7, v0
  v_lshlrev_b32 v18, 1, v9
  v_xor_b32 v18, v17, v18
  v_lshl_add_u32 v18, v18, 4, v16
  s_lshl_b32 s3, s6, 7
  s_lshl_b32 s4, s11, 17
  s_add_u32 s4, s4, s3
  s_lshl_b32 s14, s81, 15
  s_add_u32 s4, s4, s14
  v_add_u32 v5, s4, v18
  v_and_b32 v18, 1, v9
  v_lshlrev_b32 v18, 2, v18
  v_xor_b32 v18, v17, v18
  v_lshl_add_u32 v18, v18, 4, v16
  s_mul_i32 s4, s11, 458752
  s_add_u32 s4, s4, s3
  s_lshl_b32 s3, s57, 16
  s_add_u32 s4, s4, s3
  v_add_u32 v4, s4, v18
  v_lshlrev_b32 v17, 2, v9
  v_xor_b32 v17, v17, v10
  v_lshlrev_b32 v17, 4, v17
  v_mul_u32_u24 v16, 3584, v9
  v_add_u32 v16, v16, v17
  s_lshl_b32 s3, s76, 8
  s_mul_i32 s4, s11, 114688
  s_add_u32 s3, s3, s4
  s_mul_i32 s4, s61, 458752
  s_add_u32 s3, s3, s4
  s_cmp_eq_u32 s77, 1
  s_cselect_b32 s3, 2147483648, s3
  v_add_u32 v11, s3, v16
  s_mul_i32 s3, s9, 114688
  s_lshl_b32 s14, s76, 13
  s_add_u32 s3, s3, s14
  s_lshl_b32 s14, s11, 11
  s_add_u32 s3, s3, s14
  s_add_u32 s3, s3, 2097152
  v_add_u32 v28, s3, v3
  s_lshr_b32 s3, s11, 1
  s_add_u32 s3, s3, 1
  s_sub_u32 s14, 0, s3
  s_bitcmp1_b32 s11, 0
  s_cselect_b32 s3, s14, s3
  v_subrev_u32 v25, s3, v2
  v_cmp_gt_u32 vcc, 32, v25
  v_lshlrev_b32 v25, 4, v25
  v_lshl_add_u32 v25, v1, 9, v25
  v_mov_b32 v26, 0x80000000
  v_cndmask_b32 v29, v26, v25, vcc
  v_lshrrev_b32 v16, 2, v10
  v_bfe_u32 v17, v0, 1, 1
  v_and_b32 v18, 1, v0
  v_and_b32 v19, 1, v9
  v_lshl_add_u32 v19, v19, 1, v17
  s_lshl_b32 s3, s11, 2
  v_add_u32 v24, s3, v19
  v_lshlrev_b32 v25, 2, v16
  v_xor_b32 v24, v24, v25
  v_lshlrev_b32 v24, 4, v24
  v_lshl_add_u32 v24, v18, 3, v24
  v_lshl_add_u32 v25, v1, 2, v16
  v_lshl_add_u32 v12, v25, 8, v24
  v_lshrrev_b32 v24, 1, v16
  v_lshl_add_u32 v24, v24, 2, v19
  v_lshlrev_b32 v24, 4, v24
  v_lshl_add_u32 v24, v18, 3, v24
  s_lshl_b32 s3, s11, 5
  v_xor_b32 v24, s3, v24
  v_lshl_add_u32 v24, v25, 7, v24
  s_add_u32 s3, s49, 98304
  v_add_u32 v120, s3, v24
  v_xor_b32 v121, 64, v120
  v_and_b32 v24, 1, v9
  v_lshlrev_b32 v24, 1, v24
  v_lshrrev_b32 v25, 1, v16
  v_add_u32 v24, v24, v25
  v_lshlrev_b32 v24, 1, v24
  s_lshl_b32 s3, s11, 1
  v_add_u32 v26, s3, v17
  v_xor_b32 v24, v24, v26
  v_lshlrev_b32 v24, 4, v24
  v_lshl_add_u32 v24, v18, 3, v24
  v_lshl_add_u32 v27, v9, 3, v16
  v_lshl_add_u32 v64, v27, 7, v24
  v_add_u32 v64, 32768, v64
  v_lshrrev_b32 v27, 1, v9
  v_lshlrev_b32 v27, 4, v27
  v_and_b32 v25, 1, v9
  v_lshl_add_u32 v27, v25, 2, v27
  v_add_u32 v27, v27, v16
  v_lshl_add_u32 v65, v27, 7, v24
  v_add_u32 v65, 98304, v65
  v_bfe_u32 v24, v0, 1, 3
  v_xor_b32 v24, v24, v9
  v_lshlrev_b32 v24, 4, v24
  v_and_b32 v25, 7, v0
  v_lshl_add_u32 v24, v25, 7, v24
  v_bfe_u32 v25, v0, 3, 1
  v_lshl_add_u32 v66, v25, 13, v24
  v_xor_b32 v67, 64, v66
  s_lshl_b32 s3, s11, 11
  v_add_u32 v68, s3, v66
  v_add_u32 v69, s3, v67
  s_lshl_b32 s3, s60, 11
  v_xor_b32 v66, s3, v66
  v_xor_b32 v67, s3, v67
  v_lshrrev_b32 v24, 1, v9
  v_lshlrev_b32 v24, 10, v24
  v_and_b32 v25, 1, v9
  v_lshl_add_u32 v24, v25, 9, v24
  v_lshl_add_u32 v24, v10, 4, v24
  s_xor_b32 s3, s81, 0
  s_lshl_b32 s3, s3, 11
  v_add_u32 v76, s3, v24
  s_xor_b32 s3, s81, 1
  s_lshl_b32 s3, s3, 11
  v_add_u32 v77, s3, v24
  s_xor_b32 s3, s81, 2
  s_lshl_b32 s3, s3, 11
  v_add_u32 v78, s3, v24
  s_xor_b32 s3, s81, 3
  s_lshl_b32 s3, s3, 11
  v_add_u32 v79, s3, v24
  s_mov_b32 s68, 0xbdd2d3e8
  s_mov_b32 s69, 0xbdd2d3e8
  v_mov_b32 v14, 0xc0135761
  v_mov_b32 v126, 0x3f803f80
  v_add_u32 v13, s48, v3
  v_mov_b32 v72, 0x3f803f80
  v_mov_b32 v73, 0x3f803f80
  v_mov_b32 v74, 0x3f803f80
  v_mov_b32 v75, 0x3f803f80
  s_getreg_b32 s63, hwreg(HW_REG_XCC_ID)
  s_and_b32 s63, s63, 15
  s_waitcnt vmcnt(11)
  s_add_u32 m0, s50, 49152
  v_xor_b32 v6, 131072, v6
  v_xor_b32 v7, 131072, v7
  buffer_load_dwordx4 v6, s[20:23], 0 offen lds
  buffer_load_dwordx4 v7, s[20:23], s51 offen offset:1024 lds
  buffer_load_dwordx4 v6, s[20:23], s52 offen offset:2048 lds
  buffer_load_dwordx4 v7, s[20:23], s53 offen offset:3072 lds
  s_waitcnt vmcnt(11)
  s_add_u32 m0, s50, 65536
  v_xor_b32 v6, 393216, v6
  v_xor_b32 v7, 393216, v7
  buffer_load_dwordx4 v6, s[20:23], 0 offen lds
  buffer_load_dwordx4 v7, s[20:23], s51 offen offset:1024 lds
  buffer_load_dwordx4 v6, s[20:23], s52 offen offset:2048 lds
  buffer_load_dwordx4 v7, s[20:23], s53 offen offset:3072 lds
  s_barrier
  ds_read_b128 v[80:83], v68 offset:0
  ds_read_b128 v[84:87], v69 offset:0
  ds_read_b128 v[88:91], v68 offset:1024
  ds_read_b128 v[92:95], v69 offset:1024
  ds_read_b128 v[96:99], v68 offset:16384
  ds_read_b128 v[100:103], v69 offset:16384
  ds_read_b128 v[104:107], v68 offset:17408
  ds_read_b128 v[108:111], v69 offset:17408
  v_mov_b32 v20, 0
  v_mov_b32 v21, 0
  v_mov_b32 v22, 0
  v_mov_b32 v23, 0
  s_waitcnt lgkmcnt(7)
  v_dot2_f32_bf16 v20, v80, v126, v20
  v_dot2_f32_bf16 v21, v80, v80, v21
  v_dot2_f32_bf16 v20, v81, v126, v20
  v_dot2_f32_bf16 v21, v81, v81, v21
  v_dot2_f32_bf16 v20, v82, v126, v20
  v_dot2_f32_bf16 v21, v82, v82, v21
  v_dot2_f32_bf16 v20, v83, v126, v20
  v_dot2_f32_bf16 v21, v83, v83, v21
  ds_read_b128 v[128:131], v66 offset:0
  ds_read_b128 v[132:135], v66 offset:16384
  ds_read_b128 v[136:139], v67 offset:0
  ds_read_b128 v[140:143], v67 offset:16384
  s_waitcnt lgkmcnt(10)
  v_dot2_f32_bf16 v20, v84, v126, v20
  v_dot2_f32_bf16 v21, v84, v84, v21
  v_dot2_f32_bf16 v20, v85, v126, v20
  v_dot2_f32_bf16 v21, v85, v85, v21
  v_dot2_f32_bf16 v20, v86, v126, v20
  v_dot2_f32_bf16 v21, v86, v86, v21
  v_dot2_f32_bf16 v20, v87, v126, v20
  v_dot2_f32_bf16 v21, v87, v87, v21
  ds_read_b128 v[144:147], v66 offset:1024
  ds_read_b128 v[148:151], v66 offset:17408
  ds_read_b128 v[152:155], v67 offset:1024
  ds_read_b128 v[156:159], v67 offset:17408
  s_waitcnt lgkmcnt(13)
  v_dot2_f32_bf16 v20, v88, v126, v20
  v_dot2_f32_bf16 v21, v88, v88, v21
  v_dot2_f32_bf16 v20, v89, v126, v20
  v_dot2_f32_bf16 v21, v89, v89, v21
  v_dot2_f32_bf16 v20, v90, v126, v20
  v_dot2_f32_bf16 v21, v90, v90, v21
  v_dot2_f32_bf16 v20, v91, v126, v20
  v_dot2_f32_bf16 v21, v91, v91, v21
  v_xor_b32 v66, 2048, v66
  v_xor_b32 v67, 2048, v67
  ds_read_b128 v[160:163], v66 offset:0
  ds_read_b128 v[164:167], v66 offset:16384
  ds_read_b128 v[168:171], v67 offset:0
  ds_read_b128 v[172:175], v67 offset:16384
  s_waitcnt lgkmcnt(15)
  v_dot2_f32_bf16 v20, v92, v126, v20
  v_dot2_f32_bf16 v21, v92, v92, v21
  v_dot2_f32_bf16 v20, v93, v126, v20
  v_dot2_f32_bf16 v21, v93, v93, v21
  v_dot2_f32_bf16 v20, v94, v126, v20
  v_dot2_f32_bf16 v21, v94, v94, v21
  v_dot2_f32_bf16 v20, v95, v126, v20
  v_dot2_f32_bf16 v21, v95, v95, v21
  s_add_u32 m0, s50, 81920
  v_xor_b32 v6, 131072, v6
  v_xor_b32 v7, 131072, v7
  buffer_load_dwordx4 v6, s[20:23], 0 offen lds
  buffer_load_dwordx4 v7, s[20:23], s51 offen offset:1024 lds
  buffer_load_dwordx4 v6, s[20:23], s52 offen offset:2048 lds
  buffer_load_dwordx4 v7, s[20:23], s53 offen offset:3072 lds
  ds_read_b128 v[176:179], v66 offset:1024
  ds_read_b128 v[180:183], v66 offset:17408
  ds_read_b128 v[184:187], v67 offset:1024
  ds_read_b128 v[188:191], v67 offset:17408
  v_dot2_f32_bf16 v22, v96, v126, v22
  v_dot2_f32_bf16 v23, v96, v96, v23
  v_dot2_f32_bf16 v22, v97, v126, v22
  v_dot2_f32_bf16 v23, v97, v97, v23
  v_dot2_f32_bf16 v22, v98, v126, v22
  v_dot2_f32_bf16 v23, v98, v98, v23
  v_dot2_f32_bf16 v22, v99, v126, v22
  v_dot2_f32_bf16 v23, v99, v99, v23
  v_xor_b32 v66, 6144, v66
  v_xor_b32 v67, 6144, v67
  ds_read_b128 v[192:195], v66 offset:0
  ds_read_b128 v[196:199], v66 offset:16384
  ds_read_b128 v[200:203], v67 offset:0
  ds_read_b128 v[204:207], v67 offset:16384
  s_waitcnt lgkmcnt(15)
  v_dot2_f32_bf16 v22, v100, v126, v22
  v_dot2_f32_bf16 v23, v100, v100, v23
  v_dot2_f32_bf16 v22, v101, v126, v22
  v_dot2_f32_bf16 v23, v101, v101, v23
  v_dot2_f32_bf16 v22, v102, v126, v22
  v_dot2_f32_bf16 v23, v102, v102, v23
  v_dot2_f32_bf16 v22, v103, v126, v22
  v_dot2_f32_bf16 v23, v103, v103, v23
  ds_read_b128 v[208:211], v66 offset:1024
  ds_read_b128 v[212:215], v66 offset:17408
  ds_read_b128 v[216:219], v67 offset:1024
  ds_read_b128 v[220:223], v67 offset:17408
  v_dot2_f32_bf16 v22, v104, v126, v22
  v_dot2_f32_bf16 v23, v104, v104, v23
  v_dot2_f32_bf16 v22, v105, v126, v22
  v_dot2_f32_bf16 v23, v105, v105, v23
  v_dot2_f32_bf16 v22, v106, v126, v22
  v_dot2_f32_bf16 v23, v106, v106, v23
  v_dot2_f32_bf16 v22, v107, v126, v22
  v_dot2_f32_bf16 v23, v107, v107, v23
  v_xor_b32 v66, 2048, v66
  v_xor_b32 v67, 2048, v67
  ds_read_b128 v[224:227], v66 offset:0
  ds_read_b128 v[228:231], v66 offset:16384
  ds_read_b128 v[232:235], v67 offset:0
  ds_read_b128 v[236:239], v67 offset:16384
  v_dot2_f32_bf16 v22, v108, v126, v22
  v_dot2_f32_bf16 v23, v108, v108, v23
  v_dot2_f32_bf16 v22, v109, v126, v22
  v_dot2_f32_bf16 v23, v109, v109, v23
  v_dot2_f32_bf16 v22, v110, v126, v22
  v_dot2_f32_bf16 v23, v110, v110, v23
  v_dot2_f32_bf16 v22, v111, v126, v22
  v_dot2_f32_bf16 v23, v111, v111, v23
  ds_read_b128 v[240:243], v66 offset:1024
  ds_read_b128 v[244:247], v66 offset:17408
  ds_read_b128 v[248:251], v67 offset:1024
  ds_read_b128 v[252:255], v67 offset:17408
  s_lshl_b32 s3, s11, 8
  s_add_u32 s3, s3, 162816
  v_lshl_add_u32 v80, v10, 3, s3
  v_mov_b32 v24, v20
  v_mov_b32 v25, v21
  v_mov_b32 v26, v22
  v_mov_b32 v27, v23
  s_nop 0
  v_permlane32_swap_b32 v20, v24
  v_permlane32_swap_b32 v21, v25
  v_permlane32_swap_b32 v22, v26
  v_permlane32_swap_b32 v23, v27
  s_nop 1
  v_add_f32 v20, v20, v24
  v_add_f32 v21, v21, v25
  v_add_f32 v22, v22, v26
  v_add_f32 v23, v23, v27
  v_mov_b32 v24, v20
  v_mov_b32 v25, v21
  v_mov_b32 v26, v22
  v_mov_b32 v27, v23
  s_nop 0
  v_permlane16_swap_b32 v20, v24
  v_permlane16_swap_b32 v21, v25
  v_permlane16_swap_b32 v22, v26
  v_permlane16_swap_b32 v23, v27
  s_nop 1
  v_add_f32 v20, v20, v24
  v_add_f32 v21, v21, v25
  v_add_f32 v22, v22, v26
  v_add_f32 v23, v23, v27
  ds_write_b64 v80, v[20:21]
  ds_write_b64 v80, v[22:23] offset:128
  v_lshlrev_b32 v24, 3, v10
  v_add_u32 v24, 162816, v24
  buffer_load_dword v15, v70, s[40:43], 0 offen
  s_waitcnt vmcnt(15)
  v_readfirstlane_b32 s12, v127
  s_nop 3
  s_add_u32 s12, s12, 1
  s_mov_b32 s13, s12
  v_mov_b32 v127, s12
  s_lshl_b32 s4, s8, 3
  s_add_u32 s3, s78, s4
  s_cmp_eq_u32 s11, 0
  s_cselect_b32 s3, s3, 2147483648
  v_mov_b32 v25, s3
  v_mov_b32 v26, s12
  v_mov_b32 v27, s63
  buffer_store_dwordx2 v[26:27], v25, s[40:43], 0 offen sc1
  s_add_u32 m0, s49, 98304
  s_nop 0
  buffer_load_dwordx4 v5, s[24:27], 0 offen lds
  buffer_load_dwordx4 v5, s[24:27], s51 offen offset:1024 lds
  buffer_load_dwordx4 v5, s[24:27], s52 offen offset:2048 lds
  buffer_load_dwordx4 v5, s[24:27], s53 offen offset:3072 lds
  s_add_u32 m0, s49, 102400
  v_xor_b32 v5, 32768, v5
  buffer_load_dwordx4 v5, s[24:27], 0 offen lds
  s_waitcnt vmcnt(7)
  s_waitcnt lgkmcnt(0)
  s_barrier
  ds_read_b64 v[56:57], v24 offset:0
  ds_read_b64 v[104:105], v24 offset:128
  ds_read_b64 v[58:59], v24 offset:256
  ds_read_b64 v[106:107], v24 offset:384
  ds_read_b64 v[60:61], v24 offset:512
  ds_read_b64 v[108:109], v24 offset:640
  ds_read_b64 v[62:63], v24 offset:768
  ds_read_b64 v[110:111], v24 offset:896
  ds_read_b64_tr_b16 v[80:81], v64 offset:0
  ds_read_b64_tr_b16 v[82:83], v64 offset:512
  ds_read_b64_tr_b16 v[84:85], v64 offset:4096
  ds_read_b64_tr_b16 v[86:87], v64 offset:4608
  ds_read_b64_tr_b16 v[88:89], v64 offset:8192
  ds_read_b64_tr_b16 v[90:91], v64 offset:8704
  ds_read_b64_tr_b16 v[92:93], v64 offset:12288
  ds_read_b64_tr_b16 v[94:95], v64 offset:12800
  ds_read_b64_tr_b16 v[96:97], v64 offset:16384
  ds_read_b64_tr_b16 v[98:99], v64 offset:16896
  s_waitcnt lgkmcnt(10)
  s_barrier
  v_pk_add_f32 v[56:57], v[56:57], v[58:59]
  v_pk_add_f32 v[104:105], v[104:105], v[106:107]
  v_pk_add_f32 v[56:57], v[56:57], v[60:61]
  v_pk_add_f32 v[104:105], v[104:105], v[108:109]
  v_pk_add_f32 v[56:57], v[56:57], v[62:63]
  v_pk_add_f32 v[104:105], v[104:105], v[110:111]
  v_mul_f32 v56, 0xbb000000, v56
  v_mul_f32 v57, 0x3b000000, v57
  v_fma_f32 v57, -v56, v56, v57
  v_max_f32 v57, 0, v57
  v_add_f32 v57, 0x3727c5ac, v57
  v_rsq_f32 v122, v57
  s_nop 0
  v_mul_f32 v123, v56, v122
  v_mul_f32 v104, 0xbb000000, v104
  v_mul_f32 v105, 0x3b000000, v105
  v_fma_f32 v105, -v104, v104, v105
  v_max_f32 v105, 0, v105
  v_add_f32 v105, 0x3727c5ac, v105
  v_rsq_f32 v124, v105
  s_nop 0
  v_mul_f32 v125, v104, v124
  s_waitcnt lgkmcnt(8)
  v_mfma_f32_16x16x32_bf16 v[32:35], v[80:83], v[128:131], 0
  v_mfma_f32_16x16x32_bf16 v[36:39], v[80:83], v[132:135], 0
  v_mfma_f32_16x16x32_bf16 v[40:43], v[80:83], v[72:75], 0
  ds_read_b64_tr_b16 v[100:101], v64 offset:20480
  ds_read_b64_tr_b16 v[102:103], v64 offset:20992
  buffer_load_dwordx4 v5, s[24:27], s51 offen offset:1024 lds
  s_waitcnt lgkmcnt(8)
  v_mfma_f32_16x16x32_bf16 v[32:35], v[84:87], v[136:139], v[32:35]
  v_mfma_f32_16x16x32_bf16 v[36:39], v[84:87], v[140:143], v[36:39]
  v_mfma_f32_16x16x32_bf16 v[40:43], v[84:87], v[72:75], v[40:43]
  ds_read_b64_tr_b16 v[80:81], v64 offset:24576
  ds_read_b64_tr_b16 v[82:83], v64 offset:25088
  buffer_load_dwordx4 v5, s[24:27], s52 offen offset:2048 lds
  s_waitcnt lgkmcnt(8)
  v_mfma_f32_16x16x32_bf16 v[32:35], v[88:91], v[144:147], v[32:35]
  v_mfma_f32_16x16x32_bf16 v[36:39], v[88:91], v[148:151], v[36:39]
  v_mfma_f32_16x16x32_bf16 v[40:43], v[88:91], v[72:75], v[40:43]
  ds_read_b64_tr_b16 v[84:85], v64 offset:28672
  ds_read_b64_tr_b16 v[86:87], v64 offset:29184
  buffer_load_dwordx4 v5, s[24:27], s53 offen offset:3072 lds
  s_waitcnt lgkmcnt(8)
  v_mfma_f32_16x16x32_bf16 v[32:35], v[92:95], v[152:155], v[32:35]
  v_mfma_f32_16x16x32_bf16 v[36:39], v[92:95], v[156:159], v[36:39]
  v_mfma_f32_16x16x32_bf16 v[40:43], v[92:95], v[72:75], v[40:43]
  ds_read_b64_tr_b16 v[88:89], v64 offset:32768
  ds_read_b64_tr_b16 v[90:91], v64 offset:33280
  s_add_u32 m0, s49, 106496
  v_xor_b32 v5, 98304, v5
  buffer_load_dwordx4 v5, s[24:27], 0 offen lds
  s_waitcnt lgkmcnt(8)
  v_mfma_f32_16x16x32_bf16 v[32:35], v[96:99], v[160:163], v[32:35]
  v_mfma_f32_16x16x32_bf16 v[36:39], v[96:99], v[164:167], v[36:39]
  v_mfma_f32_16x16x32_bf16 v[40:43], v[96:99], v[72:75], v[40:43]
  ds_read_b64_tr_b16 v[92:93], v64 offset:36864
  ds_read_b64_tr_b16 v[94:95], v64 offset:37376
  buffer_load_dwordx4 v5, s[24:27], s51 offen offset:1024 lds
  s_waitcnt lgkmcnt(8)
  v_mfma_f32_16x16x32_bf16 v[32:35], v[100:103], v[168:171], v[32:35]
  v_mfma_f32_16x16x32_bf16 v[36:39], v[100:103], v[172:175], v[36:39]
  v_mfma_f32_16x16x32_bf16 v[40:43], v[100:103], v[72:75], v[40:43]
  ds_read_b64_tr_b16 v[96:97], v64 offset:40960
  ds_read_b64_tr_b16 v[98:99], v64 offset:41472
  buffer_load_dwordx4 v5, s[24:27], s52 offen offset:2048 lds
  s_waitcnt lgkmcnt(8)
  v_mfma_f32_16x16x32_bf16 v[32:35], v[80:83], v[176:179], v[32:35]
  v_mfma_f32_16x16x32_bf16 v[36:39], v[80:83], v[180:183], v[36:39]
  v_mfma_f32_16x16x32_bf16 v[40:43], v[80:83], v[72:75], v[40:43]
  ds_read_b64_tr_b16 v[100:101], v64 offset:45056
  ds_read_b64_tr_b16 v[102:103], v64 offset:45568
  buffer_load_dwordx4 v5, s[24:27], s53 offen offset:3072 lds
  s_waitcnt lgkmcnt(8)
  v_mfma_f32_16x16x32_bf16 v[32:35], v[84:87], v[184:187], v[32:35]
  v_mfma_f32_16x16x32_bf16 v[36:39], v[84:87], v[188:191], v[36:39]
  v_mfma_f32_16x16x32_bf16 v[40:43], v[84:87], v[72:75], v[40:43]
  ds_read_b64_tr_b16 v[80:81], v64 offset:49152
  ds_read_b64_tr_b16 v[82:83], v64 offset:49664
  s_add_u32 m0, s49, 110592
  v_xor_b32 v5, 32768, v5
  buffer_load_dwordx4 v5, s[24:27], 0 offen lds
  s_waitcnt lgkmcnt(8)
  v_mfma_f32_16x16x32_bf16 v[32:35], v[88:91], v[192:195], v[32:35]
  v_mfma_f32_16x16x32_bf16 v[36:39], v[88:91], v[196:199], v[36:39]
  v_mfma_f32_16x16x32_bf16 v[40:43], v[88:91], v[72:75], v[40:43]
  ds_read_b64_tr_b16 v[84:85], v64 offset:53248
  ds_read_b64_tr_b16 v[86:87], v64 offset:53760
  buffer_load_dwordx4 v5, s[24:27], s51 offen offset:1024 lds
  s_waitcnt lgkmcnt(8)
  v_mfma_f32_16x16x32_bf16 v[32:35], v[92:95], v[200:203], v[32:35]
  v_mfma_f32_16x16x32_bf16 v[36:39], v[92:95], v[204:207], v[36:39]
  v_mfma_f32_16x16x32_bf16 v[40:43], v[92:95], v[72:75], v[40:43]
  ds_read_b64_tr_b16 v[88:89], v64 offset:57344
  ds_read_b64_tr_b16 v[90:91], v64 offset:57856
  buffer_load_dwordx4 v5, s[24:27], s52 offen offset:2048 lds
  s_waitcnt lgkmcnt(8)
  v_mfma_f32_16x16x32_bf16 v[32:35], v[96:99], v[208:211], v[32:35]
  v_mfma_f32_16x16x32_bf16 v[36:39], v[96:99], v[212:215], v[36:39]
  v_mfma_f32_16x16x32_bf16 v[40:43], v[96:99], v[72:75], v[40:43]
  ds_read_b64_tr_b16 v[92:93], v64 offset:61440
  ds_read_b64_tr_b16 v[94:95], v64 offset:61952
  buffer_load_dwordx4 v5, s[24:27], s53 offen offset:3072 lds
  s_waitcnt lgkmcnt(8)
  v_mfma_f32_16x16x32_bf16 v[32:35], v[100:103], v[216:219], v[32:35]
  v_mfma_f32_16x16x32_bf16 v[36:39], v[100:103], v[220:223], v[36:39]
  v_mfma_f32_16x16x32_bf16 v[40:43], v[100:103], v[72:75], v[40:43]
  s_waitcnt lgkmcnt(6)
  v_mfma_f32_16x16x32_bf16 v[32:35], v[80:83], v[224:227], v[32:35]
  v_mfma_f32_16x16x32_bf16 v[36:39], v[80:83], v[228:231], v[36:39]
  v_mfma_f32_16x16x32_bf16 v[40:43], v[80:83], v[72:75], v[40:43]
  s_waitcnt lgkmcnt(4)
  v_mfma_f32_16x16x32_bf16 v[32:35], v[84:87], v[232:235], v[32:35]
  v_mfma_f32_16x16x32_bf16 v[36:39], v[84:87], v[236:239], v[36:39]
  v_mfma_f32_16x16x32_bf16 v[40:43], v[84:87], v[72:75], v[40:43]
  s_waitcnt lgkmcnt(2)
  v_mfma_f32_16x16x32_bf16 v[32:35], v[88:91], v[240:243], v[32:35]
  v_mfma_f32_16x16x32_bf16 v[36:39], v[88:91], v[244:247], v[36:39]
  v_mfma_f32_16x16x32_bf16 v[40:43], v[88:91], v[72:75], v[40:43]
  s_waitcnt lgkmcnt(0)
  v_mfma_f32_16x16x32_bf16 v[32:35], v[92:95], v[248:251], v[32:35]
  v_mfma_f32_16x16x32_bf16 v[36:39], v[92:95], v[252:255], v[36:39]
  v_mfma_f32_16x16x32_bf16 v[40:43], v[92:95], v[72:75], v[40:43]
  s_barrier
  s_add_u32 s3, s75, 7340032
  v_mov_b32 v8, s3
  s_add_u32 s3, s75, 7348224
  v_mov_b32 v6, s3
  s_lshl_b32 s3, s10, 8
  s_lshl_b32 s4, s76, 4
  s_add_u32 s3, s3, s4
  s_lshl_b32 s4, s11, 2
  s_add_u32 s3, s3, s4
  s_add_u32 s3, s3, 7352320
  v_mov_b32 v7, s3
  v_pk_mul_f32 v[32:33], v[32:33], v[122:123] op_sel_hi:[1,0]
  v_pk_mul_f32 v[34:35], v[34:35], v[122:123] op_sel_hi:[1,0]
  v_pk_mul_f32 v[36:37], v[36:37], v[124:125] op_sel_hi:[1,0]
  v_pk_mul_f32 v[38:39], v[38:39], v[124:125] op_sel_hi:[1,0]
  v_pk_fma_f32 v[32:33], v[40:41], v[122:123], v[32:33] op_sel:[0,1,0] op_sel_hi:[1,1,1]
  v_pk_fma_f32 v[34:35], v[42:43], v[122:123], v[34:35] op_sel:[0,1,0] op_sel_hi:[1,1,1]
  v_pk_fma_f32 v[36:37], v[40:41], v[124:125], v[36:37] op_sel:[0,1,0] op_sel_hi:[1,1,1]
  v_pk_fma_f32 v[38:39], v[42:43], v[124:125], v[38:39] op_sel:[0,1,0] op_sel_hi:[1,1,1]
  v_pk_mul_f32 v[80:81], v[32:33], v[32:33]
  v_pk_mul_f32 v[82:83], v[34:35], v[34:35]
  v_pk_mul_f32 v[84:85], v[36:37], v[36:37]
  v_pk_mul_f32 v[86:87], v[38:39], v[38:39]
  v_pk_fma_f32 v[80:81], v[80:81], s[68:69], v[14:15] op_sel_hi:[1,1,0]
  v_pk_fma_f32 v[82:83], v[82:83], s[68:69], v[14:15] op_sel_hi:[1,1,0]
  v_pk_fma_f32 v[84:85], v[84:85], s[68:69], v[14:15] op_sel_hi:[1,1,0]
  v_pk_fma_f32 v[86:87], v[86:87], s[68:69], v[14:15] op_sel_hi:[1,1,0]
  v_pk_mul_f32 v[80:81], v[80:81], v[32:33]
  v_pk_mul_f32 v[82:83], v[82:83], v[34:35]
  v_pk_mul_f32 v[84:85], v[84:85], v[36:37]
  v_pk_mul_f32 v[86:87], v[86:87], v[38:39]
  v_exp_f32 v80, v80
  v_exp_f32 v81, v81
  v_exp_f32 v82, v82
  v_exp_f32 v83, v83
  v_exp_f32 v84, v84
  v_exp_f32 v85, v85
  v_exp_f32 v86, v86
  v_exp_f32 v87, v87
  v_pk_add_f32 v[80:81], v[80:81], 1.0 op_sel_hi:[1,0]
  v_pk_add_f32 v[82:83], v[82:83], 1.0 op_sel_hi:[1,0]
  v_pk_add_f32 v[84:85], v[84:85], 1.0 op_sel_hi:[1,0]
  v_pk_add_f32 v[86:87], v[86:87], 1.0 op_sel_hi:[1,0]
  v_rcp_f32 v80, v80
  v_rcp_f32 v81, v81
  v_rcp_f32 v82, v82
  v_rcp_f32 v83, v83
  v_rcp_f32 v84, v84
  v_rcp_f32 v85, v85
  v_rcp_f32 v86, v86
  v_rcp_f32 v87, v87
  v_pk_mul_f32 v[80:81], v[80:81], v[32:33]
  v_pk_mul_f32 v[82:83], v[82:83], v[34:35]
  v_pk_mul_f32 v[84:85], v[84:85], v[36:37]
  v_pk_mul_f32 v[86:87], v[86:87], v[38:39]
  v_cvt_pk_bf16_f32 v60, v80, v81
  v_cvt_pk_bf16_f32 v61, v82, v83
  v_cvt_pk_bf16_f32 v62, v84, v85
  v_cvt_pk_bf16_f32 v63, v86, v87
  buffer_store_dwordx2 v[60:61], v30, s[40:43], 0 offen
  buffer_store_dwordx2 v[62:63], v30, s[40:43], 0 offen offset:256
  s_lshl_b32 s3, s7, 7
  s_lshl_b32 s14, s11, 5
  s_add_u32 s3, s3, s14
  s_add_u32 s3, s3, 7340032
  v_and_b32 v24, 7, v0
  v_lshl_add_u32 v24, v24, 2, s3
  s_waitcnt vmcnt(0)
  buffer_store_dword v127, v8, s[40:43], 0 offen
  s_add_u32 m0, s48, 32768
  s_nop 0
  buffer_load_dwordx4 v11, s[32:35], 0 offen lds
  buffer_load_dwordx4 v11, s[32:35], s54 offen offset:1024 lds
  buffer_load_dwordx4 v11, s[32:35], s55 offen offset:2048 lds
  buffer_load_dwordx4 v11, s[32:35], s56 offen offset:3072 lds
  s_add_u32 m0, s48, 36864
  v_add_u32 v11, 57344, v11
  buffer_load_dwordx4 v11, s[32:35], 0 offen lds
  buffer_load_dwordx4 v11, s[32:35], s54 offen offset:1024 lds
  s_lshr_b32 s3, s72, 2
  s_add_u32 s3, s3, 6291456
  v_lshl_add_u32 v5, v10, 3, s3
  s_barrier
  v_lshl_add_u32 v27, v10, 3, s78
  buffer_load_dword v26, v24, s[40:43], 0 offen sc1
  buffer_load_dwordx2 v[20:21], v27, s[40:43], 0 offen sc1
  buffer_load_dwordx4 v11, s[32:35], s55 offen offset:2048 lds
  buffer_load_dwordx4 v11, s[32:35], s56 offen offset:3072 lds
  s_add_u32 m0, s48, 65536
  s_mov_b32 s64, 401408
  s_cmp_eq_u32 s61, 3
  s_cselect_b32 s64, 4293533696, s64
  v_add_u32 v11, s64, v11
  buffer_load_dwordx4 v11, s[32:35], 0 offen lds
  buffer_load_dwordx4 v11, s[32:35], s54 offen offset:1024 lds
  ds_read_b64_tr_b16 v[192:193], v65 offset:0
  ds_read_b64_tr_b16 v[194:195], v65 offset:1024
  ds_read_b64_tr_b16 v[196:197], v65 offset:4096
  ds_read_b64_tr_b16 v[198:199], v65 offset:5120
  ds_read_b64_tr_b16 v[200:201], v65 offset:8192
  ds_read_b64_tr_b16 v[202:203], v65 offset:9216
  ds_read_b64_tr_b16 v[204:205], v65 offset:12288
  ds_read_b64_tr_b16 v[206:207], v65 offset:13312
  ds_read_b64_tr_b16 v[208:209], v65 offset:16384
  ds_read_b64_tr_b16 v[210:211], v65 offset:17408
  ds_read_b64_tr_b16 v[212:213], v65 offset:20480
  ds_read_b64_tr_b16 v[214:215], v65 offset:21504
  ds_read_b64_tr_b16 v[216:217], v65 offset:24576
  ds_read_b64_tr_b16 v[218:219], v65 offset:25600
  ds_read_b64_tr_b16 v[220:221], v65 offset:28672
  ds_read_b64_tr_b16 v[222:223], v65 offset:29696
  ds_read_b64_tr_b16 v[224:225], v65 offset:32768
  ds_read_b64_tr_b16 v[226:227], v65 offset:33792
  ds_read_b64_tr_b16 v[228:229], v65 offset:36864
  ds_read_b64_tr_b16 v[230:231], v65 offset:37888
  ds_read_b64_tr_b16 v[232:233], v65 offset:40960
  ds_read_b64_tr_b16 v[234:235], v65 offset:41984
  ds_read_b64_tr_b16 v[236:237], v65 offset:45056
  ds_read_b64_tr_b16 v[238:239], v65 offset:46080
  ds_read_b64_tr_b16 v[240:241], v65 offset:49152
  ds_read_b64_tr_b16 v[242:243], v65 offset:50176
  ds_read_b64_tr_b16 v[244:245], v65 offset:53248
  ds_read_b64_tr_b16 v[246:247], v65 offset:54272
  ds_read_b64_tr_b16 v[248:249], v65 offset:57344
  ds_read_b64_tr_b16 v[250:251], v65 offset:58368
  ds_read_b64_tr_b16 v[252:253], v65 offset:61440
  ds_read_b64_tr_b16 v[254:255], v65 offset:62464
  s_waitcnt lgkmcnt(0)
  s_mov_b32 s62, 1
  s_mov_b32 s65, 0x8000
  s_waitcnt vmcnt(4)
  v_cmp_ne_u32 vcc, s12, v20
  v_cmp_ne_u32 s[58:59], s12, v26
  v_cmp_ne_u32 s[16:17], s63, v21
  s_nop 3
  s_or_b64 vcc, vcc, s[58:59]
  s_or_b64 vcc, vcc, s[16:17]
  s_cbranch_scc1 L_p1_1
L_p1d_2:
  s_add_u32 m0, s48, 0
  s_add_u32 s64, s73, 0
  buffer_load_dwordx4 v29, s[40:43], s64 offen sc1 lds
  buffer_load_dwordx4 v29, s[40:43], s64 offen offset:1024 sc1 lds
  buffer_load_dwordx4 v29, s[40:43], s64 offen offset:2048 sc1 lds
  buffer_load_dwordx4 v29, s[40:43], s64 offen offset:3072 sc1 lds
  s_add_u32 m0, s48, 4096
  s_add_u32 s64, s73, 4096
  buffer_load_dwordx4 v29, s[40:43], s64 offen sc1 lds
  buffer_load_dwordx4 v29, s[40:43], s64 offen offset:1024 sc1 lds
  buffer_load_dwordx4 v29, s[40:43], s64 offen offset:2048 sc1 lds
  buffer_load_dwordx4 v29, s[40:43], s64 offen offset:3072 sc1 lds
  v_lshlrev_b32 v56, 16, v116
  v_and_b32 v57, 0xffff0000, v116
  v_lshlrev_b32 v58, 16, v117
  v_and_b32 v59, 0xffff0000, v117
  v_lshlrev_b32 v60, 16, v118
  v_and_b32 v61, 0xffff0000, v118
  v_lshlrev_b32 v62, 16, v119
  v_and_b32 v63, 0xffff0000, v119
  v_mov_b32 v20, 0
  v_mov_b32 v21, 0
  v_mov_b32 v22, 0
  v_mov_b32 v23, 0
  v_add_u32 v24, 1048576, v30
  s_waitcnt vmcnt(0)
  s_barrier
  ds_read_b128 v[80:83], v76 offset:0
  ds_read_b128 v[84:87], v76 offset:256
  ds_read_b128 v[88:91], v77 offset:0
  ds_read_b128 v[92:95], v77 offset:256
  ds_read_b128 v[96:99], v78 offset:0
  ds_read_b128 v[100:103], v78 offset:256
  ds_read_b128 v[104:107], v79 offset:0
  s_waitcnt lgkmcnt(5)
  v_mfma_f32_16x16x32_bf16 v[32:35], v[192:195], v[80:83], 0
  ds_read_b128 v[108:111], v79 offset:256
  v_mfma_f32_16x16x32_bf16 v[36:39], v[192:195], v[84:87], 0
  ds_read_b128 v[80:83], v76 offset:8192
  s_waitcnt lgkmcnt(5)
  v_mfma_f32_16x16x32_bf16 v[32:35], v[196:199], v[88:91], v[32:35]
  ds_read_b128 v[84:87], v76 offset:8448
  v_mfma_f32_16x16x32_bf16 v[36:39], v[196:199], v[92:95], v[36:39]
  ds_read_b128 v[88:91], v77 offset:8192
  s_add_u32 m0, s48, 65536
  s_nop 0
  buffer_load_dwordx4 v11, s[32:35], s55 offen offset:2048 lds
  s_waitcnt lgkmcnt(5)
  v_mfma_f32_16x16x32_bf16 v[32:35], v[200:203], v[96:99], v[32:35]
  ds_read_b128 v[92:95], v77 offset:8448
  v_mfma_f32_16x16x32_bf16 v[36:39], v[200:203], v[100:103], v[36:39]
  ds_read_b128 v[96:99], v78 offset:8192
  s_waitcnt lgkmcnt(5)
  v_mfma_f32_16x16x32_bf16 v[32:35], v[204:207], v[104:107], v[32:35]
  ds_read_b128 v[100:103], v78 offset:8448
  buffer_load_dwordx4 v11, s[32:35], s56 offen offset:3072 lds
  v_mfma_f32_16x16x32_bf16 v[36:39], v[204:207], v[108:111], v[36:39]
  ds_read_b128 v[104:107], v79 offset:8192
  s_waitcnt lgkmcnt(5)
  v_mfma_f32_16x16x32_bf16 v[32:35], v[208:211], v[80:83], v[32:35]
  ds_read_b128 v[108:111], v79 offset:8448
  v_mfma_f32_16x16x32_bf16 v[36:39], v[208:211], v[84:87], v[36:39]
  ds_read_b128 v[80:83], v76 offset:16384
  s_add_u32 m0, s48, 69632
  v_add_u32 v11, 57344, v11
  buffer_load_dwordx4 v11, s[32:35], 0 offen lds
  s_waitcnt lgkmcnt(5)
  v_mfma_f32_16x16x32_bf16 v[32:35], v[212:215], v[88:91], v[32:35]
  ds_read_b128 v[84:87], v76 offset:16640
  v_mfma_f32_16x16x32_bf16 v[36:39], v[212:215], v[92:95], v[36:39]
  ds_read_b128 v[88:91], v77 offset:16384
  s_waitcnt lgkmcnt(5)
  v_mfma_f32_16x16x32_bf16 v[32:35], v[216:219], v[96:99], v[32:35]
  ds_read_b128 v[92:95], v77 offset:16640
  buffer_load_dwordx4 v11, s[32:35], s54 offen offset:1024 lds
  v_mfma_f32_16x16x32_bf16 v[36:39], v[216:219], v[100:103], v[36:39]
  ds_read_b128 v[96:99], v78 offset:16384
  s_waitcnt lgkmcnt(5)
  v_mfma_f32_16x16x32_bf16 v[32:35], v[220:223], v[104:107], v[32:35]
  ds_read_b128 v[100:103], v78 offset:16640
  v_mfma_f32_16x16x32_bf16 v[36:39], v[220:223], v[108:111], v[36:39]
  ds_read_b128 v[104:107], v79 offset:16384
  buffer_load_dwordx4 v11, s[32:35], s55 offen offset:2048 lds
  s_waitcnt lgkmcnt(5)
  v_mfma_f32_16x16x32_bf16 v[32:35], v[224:227], v[80:83], v[32:35]
  ds_read_b128 v[108:111], v79 offset:16640
  v_mfma_f32_16x16x32_bf16 v[36:39], v[224:227], v[84:87], v[36:39]
  ds_read_b128 v[80:83], v76 offset:24576
  s_waitcnt lgkmcnt(5)
  v_mfma_f32_16x16x32_bf16 v[32:35], v[228:231], v[88:91], v[32:35]
  ds_read_b128 v[84:87], v76 offset:24832
  v_mfma_f32_16x16x32_bf16 v[36:39], v[228:231], v[92:95], v[36:39]
  ds_read_b128 v[88:91], v77 offset:24576
  buffer_load_dwordx4 v11, s[32:35], s56 offen offset:3072 lds
  s_waitcnt lgkmcnt(5)
  v_mfma_f32_16x16x32_bf16 v[32:35], v[232:235], v[96:99], v[32:35]
  ds_read_b128 v[92:95], v77 offset:24832
  v_mfma_f32_16x16x32_bf16 v[36:39], v[232:235], v[100:103], v[36:39]
  ds_read_b128 v[96:99], v78 offset:24576
  s_waitcnt lgkmcnt(5)
  v_mfma_f32_16x16x32_bf16 v[32:35], v[236:239], v[104:107], v[32:35]
  ds_read_b128 v[100:103], v78 offset:24832
  s_add_u32 m0, s48, 98304
  s_mov_b32 s64, 401408
  s_cmp_eq_u32 s61, 2
  s_cselect_b32 s64, 4293533696, s64
  v_add_u32 v11, s64, v11
  buffer_load_dwordx4 v11, s[32:35], 0 offen lds
  v_mfma_f32_16x16x32_bf16 v[36:39], v[236:239], v[108:111], v[36:39]
  ds_read_b128 v[104:107], v79 offset:24576
  s_waitcnt lgkmcnt(5)
  v_mfma_f32_16x16x32_bf16 v[32:35], v[240:243], v[80:83], v[32:35]
  ds_read_b128 v[108:111], v79 offset:24832
  v_mfma_f32_16x16x32_bf16 v[36:39], v[240:243], v[84:87], v[36:39]
  buffer_load_dwordx4 v11, s[32:35], s54 offen offset:1024 lds
  s_waitcnt lgkmcnt(4)
  v_mfma_f32_16x16x32_bf16 v[32:35], v[244:247], v[88:91], v[32:35]
  v_mfma_f32_16x16x32_bf16 v[36:39], v[244:247], v[92:95], v[36:39]
  s_waitcnt lgkmcnt(2)
  v_mfma_f32_16x16x32_bf16 v[32:35], v[248:251], v[96:99], v[32:35]
  buffer_load_dwordx4 v11, s[32:35], s55 offen offset:2048 lds
  v_mfma_f32_16x16x32_bf16 v[36:39], v[248:251], v[100:103], v[36:39]
  s_waitcnt lgkmcnt(0)
  v_mfma_f32_16x16x32_bf16 v[32:35], v[252:255], v[104:107], v[32:35]
  v_mfma_f32_16x16x32_bf16 v[36:39], v[252:255], v[108:111], v[36:39]
  buffer_load_dwordx4 v11, s[32:35], s56 offen offset:3072 lds
  s_nop 7
  v_pk_add_f32 v[32:33], v[32:33], v[56:57]
  v_pk_add_f32 v[34:35], v[34:35], v[58:59]
  v_pk_add_f32 v[36:37], v[36:37], v[60:61]
  v_pk_add_f32 v[38:39], v[38:39], v[62:63]
  v_cvt_pk_bf16_f32 v112, v32, v33
  v_cvt_pk_bf16_f32 v113, v34, v35
  v_cvt_pk_bf16_f32 v114, v36, v37
  v_cvt_pk_bf16_f32 v115, v38, v39
  s_cmp_eq_u32 s62, 1
  s_cbranch_scc0 L_slow_5
  buffer_store_dwordx2 v[112:113], v24, s[40:43], 0 offen
  buffer_store_dwordx2 v[114:115], v24, s[40:43], 0 offen offset:256
L_back_6:
  v_dot2_f32_bf16 v20, v112, v126, v20
  v_dot2_f32_bf16 v21, v112, v112, v21
  v_dot2_f32_bf16 v22, v114, v126, v22
  v_dot2_f32_bf16 v23, v114, v114, v23
  v_dot2_f32_bf16 v20, v113, v126, v20
  v_dot2_f32_bf16 v21, v113, v113, v21
  v_dot2_f32_bf16 v22, v115, v126, v22
  v_dot2_f32_bf16 v23, v115, v115, v23
  s_nop 2
  v_mov_b32 v56, v20
  v_mov_b32 v57, v21
  v_mov_b32 v58, v22
  v_mov_b32 v59, v23
  s_nop 0
  v_permlane32_swap_b32 v20, v56
  v_permlane32_swap_b32 v21, v57
  v_permlane32_swap_b32 v22, v58
  v_permlane32_swap_b32 v23, v59
  s_nop 1
  v_add_f32 v20, v20, v56
  v_add_f32 v21, v21, v57
  v_add_f32 v22, v22, v58
  v_add_f32 v23, v23, v59
  v_mov_b32 v56, v20
  v_mov_b32 v57, v21
  v_mov_b32 v58, v22
  v_mov_b32 v59, v23
  s_nop 0
  v_permlane16_swap_b32 v20, v56
  v_permlane16_swap_b32 v21, v57
  v_permlane16_swap_b32 v22, v58
  v_permlane16_swap_b32 v23, v59
  s_nop 1
  v_add_f32 v20, v20, v56
  v_add_f32 v21, v21, v57
  v_add_f32 v22, v22, v58
  v_add_f32 v23, v23, v59
  s_cmp_eq_u32 s62, 1
  s_cbranch_scc0 L_slow_7
  buffer_store_dwordx2 v[20:21], v5, s[40:43], 0 offen
  buffer_store_dwordx2 v[22:23], v5, s[40:43], 0 offen offset:128
L_back_8:
  s_waitcnt vmcnt(0)
  s_cmp_eq_u32 s62, 1
  s_cbranch_scc0 L_slow_9
  buffer_store_dword v127, v6, s[40:43], 0 offen
L_back_10:
  s_barrier
  s_cmp_eq_u32 s77, 1
  s_cbranch_scc1 L_idle
  s_lshl_b32 s3, s9, 7
  s_add_u32 s3, s3, 7348224
  v_lshl_add_u32 v24, v0, 2, s3
  s_add_u32 m0, s48, 102400
  v_add_u32 v11, 57344, v11
  buffer_load_dwordx4 v11, s[32:35], 0 offen lds
  buffer_load_dwordx4 v11, s[32:35], s54 offen offset:1024 lds
  buffer_load_dwordx4 v11, s[32:35], s55 offen offset:2048 lds
  buffer_load_dwordx4 v11, s[32:35], s56 offen offset:3072 lds
  s_add_u32 m0, s48, 131072
  s_mov_b32 s64, 401408
  s_cmp_eq_u32 s61, 1
  s_cselect_b32 s64, 4293533696, s64
  v_add_u32 v11, s64, v11
  buffer_load_dwordx4 v11, s[32:35], 0 offen lds
  buffer_load_dwordx4 v11, s[32:35], s54 offen offset:1024 lds
  v_add_u32 v25, 32768, v12
  ds_read_b64_tr_b16 v[128:129], v25 offset:0
  ds_read_b64_tr_b16 v[130:131], v25 offset:2048
  ds_read_b64_tr_b16 v[132:133], v25 offset:4096
  ds_read_b64_tr_b16 v[134:135], v25 offset:6144
  ds_read_b64_tr_b16 v[136:137], v25 offset:8192
  ds_read_b64_tr_b16 v[138:139], v25 offset:10240
  ds_read_b64_tr_b16 v[140:141], v25 offset:12288
  ds_read_b64_tr_b16 v[142:143], v25 offset:14336
  ds_read_b64_tr_b16 v[144:145], v25 offset:16384
  ds_read_b64_tr_b16 v[146:147], v25 offset:18432
  ds_read_b64_tr_b16 v[148:149], v25 offset:20480
  ds_read_b64_tr_b16 v[150:151], v25 offset:22528
  ds_read_b64_tr_b16 v[152:153], v25 offset:24576
  ds_read_b64_tr_b16 v[154:155], v25 offset:26624
  ds_read_b64_tr_b16 v[156:157], v25 offset:28672
  ds_read_b64_tr_b16 v[158:159], v25 offset:30720
  v_add_u32 v25, 65536, v12
  ds_read_b64_tr_b16 v[160:161], v25 offset:0
  ds_read_b64_tr_b16 v[162:163], v25 offset:2048
  ds_read_b64_tr_b16 v[164:165], v25 offset:4096
  ds_read_b64_tr_b16 v[166:167], v25 offset:6144
  ds_read_b64_tr_b16 v[168:169], v25 offset:8192
  ds_read_b64_tr_b16 v[170:171], v25 offset:10240
  ds_read_b64_tr_b16 v[172:173], v25 offset:12288
  ds_read_b64_tr_b16 v[174:175], v25 offset:14336
  ds_read_b64_tr_b16 v[176:177], v25 offset:16384
  ds_read_b64_tr_b16 v[178:179], v25 offset:18432
  ds_read_b64_tr_b16 v[180:181], v25 offset:20480
  ds_read_b64_tr_b16 v[182:183], v25 offset:22528
  ds_read_b64_tr_b16 v[184:185], v25 offset:24576
  ds_read_b64_tr_b16 v[186:187], v25 offset:26624
  ds_read_b64_tr_b16 v[188:189], v25 offset:28672
  ds_read_b64_tr_b16 v[190:191], v25 offset:30720
  s_add_u32 s3, s61, 0
  s_and_b32 s3, s3, 3
  s_lshl_b32 s3, s3, 13
  v_add_u32 v68, s3, v3
  s_add_u32 s3, s61, 1
  s_and_b32 s3, s3, 3
  s_lshl_b32 s3, s3, 13
  v_add_u32 v69, s3, v3
  s_add_u32 s3, s61, 2
  s_and_b32 s3, s3, 3
  s_lshl_b32 s3, s3, 13
  v_add_u32 v70, s3, v3
  s_add_u32 s3, s61, 3
  s_and_b32 s3, s3, 3
  s_lshl_b32 s3, s3, 13
  v_add_u32 v71, s3, v3
  s_add_u32 s3, s49, 32768
  s_sub_u32 s3, s48, s3
  v_add_u32 v18, s3, v120
  v_xor_b32 v19, 64, v18
  v_mov_b32 v117, 0
  v_mov_b32 v113, 0
  v_mov_b32 v65, 0
  v_mov_b32 v118, 0
  v_mov_b32 v114, 0
  v_mov_b32 v66, 0
  v_mov_b32 v119, 0
  v_mov_b32 v115, 0
  v_mov_b32 v67, 0
  s_lshr_b32 s14, s11, 1
  s_add_u32 s15, s14, s9
  s_lshl_b32 s15, s15, 13
  s_add_u32 s15, s15, 6291456
  s_lshl_b32 s14, s14, 8
  s_add_u32 s14, s14, 155648
  s_bitcmp1_b32 s11, 0
  s_cselect_b32 s15, 2147483648, s15
  s_cselect_b32 s14, 156672, s14
  v_add_u32 v72, s15, v3
  v_lshl_add_u32 v73, v10, 4, s14
  v_mov_b32 v20, 0
  v_mov_b32 v21, 0
  v_mov_b32 v22, 0
  v_mov_b32 v23, 0
  s_waitcnt lgkmcnt(0)
  buffer_load_dword v26, v24, s[40:43], 0 offen sc1
  v_dot2_f32_bf16 v20, v128, v126, v20
  v_dot2_f32_bf16 v21, v129, v126, v21
  v_dot2_f32_bf16 v22, v130, v126, v22
  v_dot2_f32_bf16 v23, v131, v126, v23
  buffer_load_dwordx4 v11, s[32:35], s55 offen offset:2048 lds
  v_dot2_f32_bf16 v20, v132, v126, v20
  v_dot2_f32_bf16 v21, v133, v126, v21
  v_dot2_f32_bf16 v22, v134, v126, v22
  v_dot2_f32_bf16 v23, v135, v126, v23
  buffer_load_dwordx4 v11, s[32:35], s56 offen offset:3072 lds
  v_dot2_f32_bf16 v20, v136, v126, v20
  v_dot2_f32_bf16 v21, v137, v126, v21
  v_dot2_f32_bf16 v22, v138, v126, v22
  v_dot2_f32_bf16 v23, v139, v126, v23
  s_add_u32 m0, s48, 135168
  v_add_u32 v11, 57344, v11
  buffer_load_dwordx4 v11, s[32:35], 0 offen lds
  v_dot2_f32_bf16 v20, v140, v126, v20
  v_dot2_f32_bf16 v21, v141, v126, v21
  v_dot2_f32_bf16 v22, v142, v126, v22
  v_dot2_f32_bf16 v23, v143, v126, v23
  buffer_load_dwordx4 v11, s[32:35], s54 offen offset:1024 lds
  v_dot2_f32_bf16 v20, v144, v126, v20
  v_dot2_f32_bf16 v21, v145, v126, v21
  v_dot2_f32_bf16 v22, v146, v126, v22
  v_dot2_f32_bf16 v23, v147, v126, v23
  buffer_load_dwordx4 v11, s[32:35], s55 offen offset:2048 lds
  v_dot2_f32_bf16 v20, v148, v126, v20
  v_dot2_f32_bf16 v21, v149, v126, v21
  v_dot2_f32_bf16 v22, v150, v126, v22
  v_dot2_f32_bf16 v23, v151, v126, v23
  buffer_load_dwordx4 v11, s[32:35], s56 offen offset:3072 lds
  v_dot2_f32_bf16 v20, v152, v126, v20
  v_dot2_f32_bf16 v21, v153, v126, v21
  v_dot2_f32_bf16 v22, v154, v126, v22
  v_dot2_f32_bf16 v23, v155, v126, v23
  v_dot2_f32_bf16 v20, v156, v126, v20
  v_dot2_f32_bf16 v21, v157, v126, v21
  v_dot2_f32_bf16 v22, v158, v126, v22
  v_dot2_f32_bf16 v23, v159, v126, v23
  v_dot2_f32_bf16 v20, v160, v126, v20
  v_dot2_f32_bf16 v21, v161, v126, v21
  v_dot2_f32_bf16 v22, v162, v126, v22
  v_dot2_f32_bf16 v23, v163, v126, v23
  v_dot2_f32_bf16 v20, v164, v126, v20
  v_dot2_f32_bf16 v21, v165, v126, v21
  v_dot2_f32_bf16 v22, v166, v126, v22
  v_dot2_f32_bf16 v23, v167, v126, v23
  v_dot2_f32_bf16 v20, v168, v126, v20
  v_dot2_f32_bf16 v21, v169, v126, v21
  v_dot2_f32_bf16 v22, v170, v126, v22
  v_dot2_f32_bf16 v23, v171, v126, v23
  v_dot2_f32_bf16 v20, v172, v126, v20
  v_dot2_f32_bf16 v21, v173, v126, v21
  v_dot2_f32_bf16 v22, v174, v126, v22
  v_dot2_f32_bf16 v23, v175, v126, v23
  v_dot2_f32_bf16 v20, v176, v126, v20
  v_dot2_f32_bf16 v21, v177, v126, v21
  v_dot2_f32_bf16 v22, v178, v126, v22
  v_dot2_f32_bf16 v23, v179, v126, v23
  v_dot2_f32_bf16 v20, v180, v126, v20
  v_dot2_f32_bf16 v21, v181, v126, v21
  v_dot2_f32_bf16 v22, v182, v126, v22
  v_dot2_f32_bf16 v23, v183, v126, v23
  v_dot2_f32_bf16 v20, v184, v126, v20
  v_dot2_f32_bf16 v21, v185, v126, v21
  v_dot2_f32_bf16 v22, v186, v126, v22
  v_dot2_f32_bf16 v23, v187, v126, v23
  v_dot2_f32_bf16 v20, v188, v126, v20
  v_dot2_f32_bf16 v21, v189, v126, v21
  v_dot2_f32_bf16 v22, v190, v126, v22
  v_dot2_f32_bf16 v23, v191, v126, v23
  s_barrier
  s_waitcnt vmcnt(6)
  v_cmp_ne_u32 vcc, s12, v26
  s_mov_b32 s65, 0x8000
  s_nop 3
  s_cmp_eq_u64 vcc, 0
  s_cbranch_scc0 L_poll_11
L_polld_12:
  s_add_u32 m0, s48, 0
  s_add_u32 s64, s74, 1048576
  buffer_load_dwordx4 v3, s[40:43], s64 offen sc1 lds
  buffer_load_dwordx4 v3, s[40:43], s64 offen offset:1024 sc1 lds
  buffer_load_dwordx4 v3, s[40:43], s64 offen offset:2048 sc1 lds
  buffer_load_dwordx4 v3, s[40:43], s64 offen offset:3072 sc1 lds
  s_add_u32 m0, s48, 4096
  s_add_u32 s64, s74, 1052672
  buffer_load_dwordx4 v3, s[40:43], s64 offen sc1 lds
  buffer_load_dwordx4 v3, s[40:43], s64 offen offset:1024 sc1 lds
  buffer_load_dwordx4 v3, s[40:43], s64 offen offset:2048 sc1 lds
  buffer_load_dwordx4 v3, s[40:43], s64 offen offset:3072 sc1 lds
  buffer_load_dwordx4 v[80:83], v72, s[40:43], 0 offen sc1
  buffer_load_dwordx4 v[84:87], v72, s[40:43], 0 offen offset:1024 sc1
  buffer_load_dwordx4 v[88:91], v72, s[40:43], 0 offen offset:2048 sc1
  buffer_load_dwordx4 v[92:95], v72, s[40:43], 0 offen offset:3072 sc1
  buffer_load_dwordx4 v[96:99], v72, s[40:43], s66 offen sc1
  buffer_load_dwordx4 v[100:103], v72, s[40:43], s66 offen offset:1024 sc1
  buffer_load_dwordx4 v[104:107], v72, s[40:43], s66 offen offset:2048 sc1
  buffer_load_dwordx4 v[108:111], v72, s[40:43], s66 offen offset:3072 sc1
  s_waitcnt vmcnt(16)
  s_barrier
  v_add_u32 v25, 98304, v12
  ds_read_b64_tr_b16 v[192:193], v25 offset:0
  ds_read_b64_tr_b16 v[194:195], v25 offset:2048
  ds_read_b64_tr_b16 v[196:197], v25 offset:4096
  ds_read_b64_tr_b16 v[198:199], v25 offset:6144
  ds_read_b64_tr_b16 v[200:201], v25 offset:8192
  ds_read_b64_tr_b16 v[202:203], v25 offset:10240
  ds_read_b64_tr_b16 v[204:205], v25 offset:12288
  ds_read_b64_tr_b16 v[206:207], v25 offset:14336
  ds_read_b64_tr_b16 v[208:209], v25 offset:16384
  ds_read_b64_tr_b16 v[210:211], v25 offset:18432
  ds_read_b64_tr_b16 v[212:213], v25 offset:20480
  ds_read_b64_tr_b16 v[214:215], v25 offset:22528
  ds_read_b64_tr_b16 v[216:217], v25 offset:24576
  ds_read_b64_tr_b16 v[218:219], v25 offset:26624
  ds_read_b64_tr_b16 v[220:221], v25 offset:28672
  ds_read_b64_tr_b16 v[222:223], v25 offset:30720
  s_add_u32 m0, s48, 32768
  s_add_u32 s64, s74, 1081344
  buffer_load_dwordx4 v3, s[40:43], s64 offen sc1 lds
  buffer_load_dwordx4 v3, s[40:43], s64 offen offset:1024 sc1 lds
  buffer_load_dwordx4 v3, s[40:43], s64 offen offset:2048 sc1 lds
  buffer_load_dwordx4 v3, s[40:43], s64 offen offset:3072 sc1 lds
  s_add_u32 m0, s48, 36864
  s_add_u32 s64, s74, 1085440
  buffer_load_dwordx4 v3, s[40:43], s64 offen sc1 lds
  buffer_load_dwordx4 v3, s[40:43], s64 offen offset:1024 sc1 lds
  buffer_load_dwordx4 v3, s[40:43], s64 offen offset:2048 sc1 lds
  buffer_load_dwordx4 v3, s[40:43], s64 offen offset:3072 sc1 lds
  s_waitcnt lgkmcnt(0)
  v_add_u32 v25, 131072, v12
  ds_read_b64_tr_b16 v[224:225], v25 offset:0
  ds_read_b64_tr_b16 v[226:227], v25 offset:2048
  ds_read_b64_tr_b16 v[228:229], v25 offset:4096
  ds_read_b64_tr_b16 v[230:231], v25 offset:6144
  ds_read_b64_tr_b16 v[232:233], v25 offset:8192
  ds_read_b64_tr_b16 v[234:235], v25 offset:10240
  ds_read_b64_tr_b16 v[236:237], v25 offset:12288
  ds_read_b64_tr_b16 v[238:239], v25 offset:14336
  ds_read_b64_tr_b16 v[240:241], v25 offset:16384
  ds_read_b64_tr_b16 v[242:243], v25 offset:18432
  ds_read_b64_tr_b16 v[244:245], v25 offset:20480
  ds_read_b64_tr_b16 v[246:247], v25 offset:22528
  ds_read_b64_tr_b16 v[248:249], v25 offset:24576
  ds_read_b64_tr_b16 v[250:251], v25 offset:26624
  ds_read_b64_tr_b16 v[252:253], v25 offset:28672
  ds_read_b64_tr_b16 v[254:255], v25 offset:30720
  v_dot2_f32_bf16 v20, v192, v126, v20
  v_dot2_f32_bf16 v21, v193, v126, v21
  v_dot2_f32_bf16 v22, v194, v126, v22
  v_dot2_f32_bf16 v23, v195, v126, v23
  s_add_u32 m0, s48, 65536
  s_nop 0
  buffer_load_dwordx4 v4, s[36:39], 0 offen lds
  v_dot2_f32_bf16 v20, v196, v126, v20
  v_dot2_f32_bf16 v21, v197, v126, v21
  v_dot2_f32_bf16 v22, v198, v126, v22
  v_dot2_f32_bf16 v23, v199, v126, v23
  buffer_load_dwordx4 v4, s[36:39], s51 offen offset:1024 lds
  v_dot2_f32_bf16 v20, v200, v126, v20
  v_dot2_f32_bf16 v21, v201, v126, v21
  v_dot2_f32_bf16 v22, v202, v126, v22
  v_dot2_f32_bf16 v23, v203, v126, v23
  buffer_load_dwordx4 v4, s[36:39], s52 offen offset:2048 lds
  v_dot2_f32_bf16 v20, v204, v126, v20
  v_dot2_f32_bf16 v21, v205, v126, v21
  v_dot2_f32_bf16 v22, v206, v126, v22
  v_dot2_f32_bf16 v23, v207, v126, v23
  buffer_load_dwordx4 v4, s[36:39], s53 offen offset:3072 lds
  v_dot2_f32_bf16 v20, v208, v126, v20
  v_dot2_f32_bf16 v21, v209, v126, v21
  v_dot2_f32_bf16 v22, v210, v126, v22
  v_dot2_f32_bf16 v23, v211, v126, v23
  v_dot2_f32_bf16 v20, v212, v126, v20
  v_dot2_f32_bf16 v21, v213, v126, v21
  v_dot2_f32_bf16 v22, v214, v126, v22
  v_dot2_f32_bf16 v23, v215, v126, v23
  v_dot2_f32_bf16 v20, v216, v126, v20
  v_dot2_f32_bf16 v21, v217, v126, v21
  v_dot2_f32_bf16 v22, v218, v126, v22
  v_dot2_f32_bf16 v23, v219, v126, v23
  v_dot2_f32_bf16 v20, v220, v126, v20
  v_dot2_f32_bf16 v21, v221, v126, v21
  v_dot2_f32_bf16 v22, v222, v126, v22
  v_dot2_f32_bf16 v23, v223, v126, v23
  s_waitcnt lgkmcnt(0)
  s_barrier
  v_dot2_f32_bf16 v20, v224, v126, v20
  v_dot2_f32_bf16 v21, v225, v126, v21
  v_dot2_f32_bf16 v22, v226, v126, v22
  v_dot2_f32_bf16 v23, v227, v126, v23
  s_add_u32 m0, s48, 69632
  v_add_u32 v4, 32768, v4
  buffer_load_dwordx4 v4, s[36:39], 0 offen lds
  v_dot2_f32_bf16 v20, v228, v126, v20
  v_dot2_f32_bf16 v21, v229, v126, v21
  v_dot2_f32_bf16 v22, v230, v126, v22
  v_dot2_f32_bf16 v23, v231, v126, v23
  buffer_load_dwordx4 v4, s[36:39], s51 offen offset:1024 lds
  v_dot2_f32_bf16 v20, v232, v126, v20
  v_dot2_f32_bf16 v21, v233, v126, v21
  v_dot2_f32_bf16 v22, v234, v126, v22
  v_dot2_f32_bf16 v23, v235, v126, v23
  buffer_load_dwordx4 v4, s[36:39], s52 offen offset:2048 lds
  v_dot2_f32_bf16 v20, v236, v126, v20
  v_dot2_f32_bf16 v21, v237, v126, v21
  v_dot2_f32_bf16 v22, v238, v126, v22
  v_dot2_f32_bf16 v23, v239, v126, v23
  buffer_load_dwordx4 v4, s[36:39], s53 offen offset:3072 lds
  s_mov_b32 s64, 32768
  s_cmp_eq_u32 s57, 6
  s_cselect_b32 s64, 4294541312, s64
  v_add_u32 v4, s64, v4
  v_dot2_f32_bf16 v20, v240, v126, v20
  v_dot2_f32_bf16 v21, v241, v126, v21
  v_dot2_f32_bf16 v22, v242, v126, v22
  v_dot2_f32_bf16 v23, v243, v126, v23
  v_dot2_f32_bf16 v20, v244, v126, v20
  v_dot2_f32_bf16 v21, v245, v126, v21
  v_dot2_f32_bf16 v22, v246, v126, v22
  v_dot2_f32_bf16 v23, v247, v126, v23
  v_dot2_f32_bf16 v20, v248, v126, v20
  v_dot2_f32_bf16 v21, v249, v126, v21
  v_dot2_f32_bf16 v22, v250, v126, v22
  v_dot2_f32_bf16 v23, v251, v126, v23
  v_dot2_f32_bf16 v20, v252, v126, v20
  v_dot2_f32_bf16 v21, v253, v126, v21
  v_dot2_f32_bf16 v22, v254, v126, v22
  v_dot2_f32_bf16 v23, v255, v126, v23
  s_lshl_b32 s3, s10, 7
  s_add_u32 s3, s3, 7356416
  v_add_f32 v20, v20, v21
  v_add_f32 v22, v22, v23
  s_or_b32 s14, s8, s11
  s_cmp_eq_u32 s14, 0
  v_add_f32 v20, v20, v22
  s_cselect_b32 s3, s3, 2147483648
  v_mov_b32 v26, s3
  v_mov_b32 v21, v20
  s_nop 1
  v_permlane32_swap_b32 v20, v21
  s_nop 1
  v_add_f32 v20, v20, v21
  v_cvt_pk_bf16_f32 v21, v20, v20
  v_lshlrev_b32 v22, 16, v21
  v_sub_f32 v22, v20, v22
  v_cvt_pk_bf16_f32 v64, v20, v22
  v_cmp_gt_u32 vcc, 32, v0
  s_waitcnt vmcnt(16)
  v_pk_add_f32 v[80:81], v[80:81], v[84:85]
  v_pk_add_f32 v[82:83], v[82:83], v[86:87]
  v_pk_add_f32 v[80:81], v[80:81], v[88:89]
  v_pk_add_f32 v[82:83], v[82:83], v[90:91]
  v_pk_add_f32 v[80:81], v[80:81], v[92:93]
  v_pk_add_f32 v[82:83], v[82:83], v[94:95]
  v_pk_add_f32 v[80:81], v[80:81], v[96:97]
  v_pk_add_f32 v[82:83], v[82:83], v[98:99]
  v_pk_add_f32 v[80:81], v[80:81], v[100:101]
  v_pk_add_f32 v[82:83], v[82:83], v[102:103]
  v_pk_add_f32 v[80:81], v[80:81], v[104:105]
  v_pk_add_f32 v[82:83], v[82:83], v[106:107]
  v_pk_add_f32 v[80:81], v[80:81], v[108:109]
  v_pk_add_f32 v[82:83], v[82:83], v[110:111]
  v_cndmask_b32 v64, v65, v64, vcc
  v_mov_b32 v84, v80
  v_mov_b32 v85, v81
  v_mov_b32 v86, v82
  v_mov_b32 v87, v83
  s_nop 0
  v_permlane32_swap_b32 v80, v84
  v_permlane32_swap_b32 v81, v85
  v_permlane32_swap_b32 v82, v86
  v_permlane32_swap_b32 v83, v87
  s_nop 1
  v_add_f32 v80, v80, v84
  v_add_f32 v81, v81, v85
  v_add_f32 v82, v82, v86
  v_add_f32 v83, v83, v87
  v_mov_b32 v84, v80
  v_mov_b32 v85, v81
  v_mov_b32 v86, v82
  v_mov_b32 v87, v83
  s_nop 0
  v_permlane16_swap_b32 v80, v84
  v_permlane16_swap_b32 v81, v85
  v_permlane16_swap_b32 v82, v86
  v_permlane16_swap_b32 v83, v87
  s_nop 1
  v_add_f32 v80, v80, v84
  v_add_f32 v81, v81, v85
  v_add_f32 v82, v82, v86
  v_add_f32 v83, v83, v87
  v_mul_f32 v80, 0xbb000000, v80
  v_mul_f32 v81, 0x3b000000, v81
  v_fma_f32 v81, -v80, v80, v81
  v_max_f32 v81, 0, v81
  v_add_f32 v81, 0x3727c5ac, v81
  v_rsq_f32 v88, v81
  v_cvt_pk_bf16_f32 v89, v80, v80
  v_mul_f32 v82, 0xbb000000, v82
  v_mul_f32 v83, 0x3b000000, v83
  v_fma_f32 v83, -v82, v82, v83
  v_max_f32 v83, 0, v83
  v_add_f32 v83, 0x3727c5ac, v83
  v_rsq_f32 v90, v83
  v_cvt_pk_bf16_f32 v91, v82, v82
  ds_write_b128 v73, v[88:91]
  buffer_store_dword v127, v26, s[40:43], 0 offen sc1
  v_lshlrev_b32 v24, 3, v2
  v_add_u32 v24, 155648, v24
  s_add_u32 m0, s49, 98304
  s_nop 0
  buffer_load_dwordx4 v4, s[36:39], 0 offen lds
  buffer_load_dwordx4 v4, s[36:39], s51 offen offset:1024 lds
  buffer_load_dwordx4 v4, s[36:39], s52 offen offset:2048 lds
  buffer_load_dwordx4 v4, s[36:39], s53 offen offset:3072 lds
  v_sub_u32 v25, v28, v3
  v_mul_u32_u24 v26, 114688, v9
  v_lshl_add_u32 v26, v10, 7, v26
  v_add_u32 v25, v25, v26
  v_cmp_gt_u32 vcc, 32, v0
  v_mov_b32 v26, 0x80000000
  s_nop 0
  v_cndmask_b32 v25, v26, v25, vcc
  buffer_load_dword v15, v25, s[40:43], 0 offen
  s_waitcnt lgkmcnt(0)
  s_barrier
  ds_read_b32 v122, v24
  ds_read_b32 v116, v24 offset:4
  ds_read_b32 v124, v24 offset:256
  ds_read_b32 v112, v24 offset:260
  ds_read_b128 a[224:227], v68 offset:0
  ds_read_b128 a[228:231], v68 offset:1024
  ds_read_b128 a[232:235], v68 offset:2048
  ds_read_b128 a[236:239], v68 offset:3072
  ds_read_b128 a[240:243], v68 offset:4096
  ds_read_b128 a[244:247], v68 offset:5120
  s_waitcnt lgkmcnt(6)
  v_mfma_f32_32x32x16_bf16 v[32:47], v[64:67], v[116:119], 0
  s_waitcnt lgkmcnt(4)
  v_mfma_f32_32x32x16_bf16 v[32:47], v[128:131], a[224:227], v[32:47]
  ds_read_b128 a[248:251], v68 offset:6144
  v_mfma_f32_32x32x16_bf16 v[32:47], v[132:135], a[228:231], v[32:47]
  ds_read_b128 a[252:255], v68 offset:7168
  s_waitcnt lgkmcnt(4)
  v_mfma_f32_32x32x16_bf16 v[32:47], v[136:139], a[232:235], v[32:47]
  ds_read_b128 a[224:227], v69 offset:0
  s_add_u32 m0, s49, 102400
  v_add_u32 v4, 32768, v4
  buffer_load_dwordx4 v4, s[36:39], 0 offen lds
  v_mfma_f32_32x32x16_bf16 v[32:47], v[140:143], a[236:239], v[32:47]
  ds_read_b128 a[228:231], v69 offset:1024
  s_waitcnt lgkmcnt(4)
  v_mfma_f32_32x32x16_bf16 v[32:47], v[144:147], a[240:243], v[32:47]
  ds_read_b128 a[232:235], v69 offset:2048
  v_mfma_f32_32x32x16_bf16 v[32:47], v[148:151], a[244:247], v[32:47]
  ds_read_b128 a[236:239], v69 offset:3072
  buffer_load_dwordx4 v4, s[36:39], s51 offen offset:1024 lds
  s_waitcnt lgkmcnt(4)
  v_mfma_f32_32x32x16_bf16 v[32:47], v[152:155], a[248:251], v[32:47]
  ds_read_b128 a[240:243], v69 offset:4096
  v_mfma_f32_32x32x16_bf16 v[32:47], v[156:159], a[252:255], v[32:47]
  ds_read_b128 a[244:247], v69 offset:5120
  buffer_load_dwordx4 v4, s[36:39], s52 offen offset:2048 lds
  s_waitcnt lgkmcnt(4)
  v_mfma_f32_32x32x16_bf16 v[32:47], v[160:163], a[224:227], v[32:47]
  ds_read_b128 a[248:251], v69 offset:6144
  v_mfma_f32_32x32x16_bf16 v[32:47], v[164:167], a[228:231], v[32:47]
  ds_read_b128 a[252:255], v69 offset:7168
  s_waitcnt lgkmcnt(4)
  v_mfma_f32_32x32x16_bf16 v[32:47], v[168:171], a[232:235], v[32:47]
  ds_read_b128 a[224:227], v70 offset:0
  buffer_load_dwordx4 v4, s[36:39], s53 offen offset:3072 lds
  s_mov_b32 s64, 32768
  s_cmp_eq_u32 s57, 5
  s_cselect_b32 s64, 4294541312, s64
  v_add_u32 v4, s64, v4
  v_mfma_f32_32x32x16_bf16 v[32:47], v[172:175], a[236:239], v[32:47]
  ds_read_b128 a[228:231], v70 offset:1024
  s_waitcnt lgkmcnt(4)
  v_mfma_f32_32x32x16_bf16 v[32:47], v[176:179], a[240:243], v[32:47]
  ds_read_b128 a[232:235], v70 offset:2048
  v_mfma_f32_32x32x16_bf16 v[32:47], v[180:183], a[244:247], v[32:47]
  ds_read_b128 a[236:239], v70 offset:3072
  s_waitcnt vmcnt(10)
  ds_read_b64_tr_b16 a[0:1], v18 offset:0
  ds_read_b64_tr_b16 a[2:3], v18 offset:1024
  s_waitcnt lgkmcnt(6)
  v_mfma_f32_32x32x16_bf16 v[32:47], v[184:187], a[248:251], v[32:47]
  ds_read_b128 a[240:243], v70 offset:4096
  v_mfma_f32_32x32x16_bf16 v[32:47], v[188:191], a[252:255], v[32:47]
  ds_read_b128 a[244:247], v70 offset:5120
  ds_read_b64_tr_b16 a[4:5], v19 offset:0
  ds_read_b64_tr_b16 a[6:7], v19 offset:1024
  s_waitcnt lgkmcnt(8)
  v_mfma_f32_32x32x16_bf16 v[32:47], v[192:195], a[224:227], v[32:47]
  ds_read_b128 a[248:251], v70 offset:6144
  v_mfma_f32_32x32x16_bf16 v[32:47], v[196:199], a[228:231], v[32:47]
  ds_read_b128 a[252:255], v70 offset:7168
  s_waitcnt lgkmcnt(8)
  v_mfma_f32_32x32x16_bf16 v[32:47], v[200:203], a[232:235], v[32:47]
  ds_read_b128 a[224:227], v71 offset:0
  ds_read_b64_tr_b16 a[8:9], v18 offset:2048
  ds_read_b64_tr_b16 a[10:11], v18 offset:3072
  v_mfma_f32_32x32x16_bf16 v[32:47], v[204:207], a[236:239], v[32:47]
  ds_read_b128 a[228:231], v71 offset:1024
  s_waitcnt lgkmcnt(8)
  v_mfma_f32_32x32x16_bf16 v[32:47], v[208:211], a[240:243], v[32:47]
  ds_read_b128 a[232:235], v71 offset:2048
  v_mfma_f32_32x32x16_bf16 v[32:47], v[212:215], a[244:247], v[32:47]
  ds_read_b128 a[236:239], v71 offset:3072
  ds_read_b64_tr_b16 a[12:13], v19 offset:2048
  ds_read_b64_tr_b16 a[14:15], v19 offset:3072
  s_waitcnt lgkmcnt(8)
  v_mfma_f32_32x32x16_bf16 v[32:47], v[216:219], a[248:251], v[32:47]
  ds_read_b128 a[240:243], v71 offset:4096
  v_mfma_f32_32x32x16_bf16 v[32:47], v[220:223], a[252:255], v[32:47]
  ds_read_b128 a[244:247], v71 offset:5120
  ds_read_b64_tr_b16 a[16:17], v18 offset:4096
  ds_read_b64_tr_b16 a[18:19], v18 offset:5120
  s_waitcnt lgkmcnt(8)
  v_mfma_f32_32x32x16_bf16 v[32:47], v[224:227], a[224:227], v[32:47]
  ds_read_b128 a[248:251], v71 offset:6144
  v_mfma_f32_32x32x16_bf16 v[32:47], v[228:231], a[228:231], v[32:47]
  ds_read_b128 a[252:255], v71 offset:7168
  s_waitcnt lgkmcnt(8)
  v_mfma_f32_32x32x16_bf16 v[32:47], v[232:235], a[232:235], v[32:47]
  ds_read_b64_tr_b16 a[20:21], v19 offset:4096
  ds_read_b64_tr_b16 a[22:23], v19 offset:5120
  v_mfma_f32_32x32x16_bf16 v[32:47], v[236:239], a[236:239], v[32:47]
  s_waitcnt lgkmcnt(6)
  v_mfma_f32_32x32x16_bf16 v[32:47], v[240:243], a[240:243], v[32:47]
  v_mfma_f32_32x32x16_bf16 v[32:47], v[244:247], a[244:247], v[32:47]
  ds_read_b64_tr_b16 a[24:25], v18 offset:6144
  ds_read_b64_tr_b16 a[26:27], v18 offset:7168
  s_waitcnt lgkmcnt(4)
  v_mfma_f32_32x32x16_bf16 v[32:47], v[248:251], a[248:251], v[32:47]
  v_mfma_f32_32x32x16_bf16 v[32:47], v[252:255], a[252:255], v[32:47]
  ds_read_b64_tr_b16 a[28:29], v19 offset:6144
  ds_read_b64_tr_b16 a[30:31], v19 offset:7168
  s_barrier
  s_nop 9
  v_pk_mul_f32 v[32:33], v[32:33], v[122:123] op_sel_hi:[1,0]
  v_pk_mul_f32 v[34:35], v[34:35], v[122:123] op_sel_hi:[1,0]
  v_pk_mul_f32 v[36:37], v[36:37], v[122:123] op_sel_hi:[1,0]
  v_pk_mul_f32 v[38:39], v[38:39], v[122:123] op_sel_hi:[1,0]
  v_pk_mul_f32 v[40:41], v[40:41], v[122:123] op_sel_hi:[1,0]
  v_pk_mul_f32 v[42:43], v[42:43], v[122:123] op_sel_hi:[1,0]
  v_pk_mul_f32 v[44:45], v[44:45], v[122:123] op_sel_hi:[1,0]
  v_pk_mul_f32 v[46:47], v[46:47], v[122:123] op_sel_hi:[1,0]
  v_pk_mul_f32 v[80:81], v[32:33], v[32:33]
  v_pk_mul_f32 v[82:83], v[34:35], v[34:35]
  v_pk_mul_f32 v[84:85], v[36:37], v[36:37]
  v_pk_mul_f32 v[86:87], v[38:39], v[38:39]
  v_pk_mul_f32 v[88:89], v[40:41], v[40:41]
  v_pk_mul_f32 v[90:91], v[42:43], v[42:43]
  v_pk_mul_f32 v[92:93], v[44:45], v[44:45]
  v_pk_mul_f32 v[94:95], v[46:47], v[46:47]
  s_waitcnt lgkmcnt(0)
  s_add_u32 m0, s48, 65536
  s_nop 0
  buffer_load_dwordx4 v4, s[36:39], 0 offen lds
  v_pk_fma_f32 v[80:81], v[80:81], s[68:69], v[14:15] op_sel_hi:[1,1,0]
  v_pk_fma_f32 v[82:83], v[82:83], s[68:69], v[14:15] op_sel_hi:[1,1,0]
  v_pk_fma_f32 v[84:85], v[84:85], s[68:69], v[14:15] op_sel_hi:[1,1,0]
  v_pk_fma_f32 v[86:87], v[86:87], s[68:69], v[14:15] op_sel_hi:[1,1,0]
  v_pk_fma_f32 v[88:89], v[88:89], s[68:69], v[14:15] op_sel_hi:[1,1,0]
  v_pk_fma_f32 v[90:91], v[90:91], s[68:69], v[14:15] op_sel_hi:[1,1,0]
  v_pk_fma_f32 v[92:93], v[92:93], s[68:69], v[14:15] op_sel_hi:[1,1,0]
  v_pk_fma_f32 v[94:95], v[94:95], s[68:69], v[14:15] op_sel_hi:[1,1,0]
  buffer_load_dwordx4 v4, s[36:39], s51 offen offset:1024 lds
  v_pk_mul_f32 v[80:81], v[80:81], v[32:33]
  v_pk_mul_f32 v[82:83], v[82:83], v[34:35]
  v_pk_mul_f32 v[84:85], v[84:85], v[36:37]
  v_pk_mul_f32 v[86:87], v[86:87], v[38:39]
  v_pk_mul_f32 v[88:89], v[88:89], v[40:41]
  v_pk_mul_f32 v[90:91], v[90:91], v[42:43]
  v_pk_mul_f32 v[92:93], v[92:93], v[44:45]
  v_pk_mul_f32 v[94:95], v[94:95], v[46:47]
  ds_read_b128 a[224:227], v68 offset:32768
  ds_read_b128 a[228:231], v68 offset:33792
  ds_read_b128 a[232:235], v68 offset:34816
  ds_read_b128 a[236:239], v68 offset:35840
  ds_read_b128 a[240:243], v68 offset:36864
  ds_read_b128 a[244:247], v68 offset:37888
  v_mfma_f32_32x32x16_bf16 v[48:63], v[64:67], v[112:115], 0
  s_waitcnt lgkmcnt(4)
  v_mfma_f32_32x32x16_bf16 v[48:63], v[128:131], a[224:227], v[48:63]
  ds_read_b128 a[248:251], v68 offset:38912
  v_exp_f32 v80, v80
  v_exp_f32 v81, v81
  v_exp_f32 v82, v82
  v_mfma_f32_32x32x16_bf16 v[48:63], v[132:135], a[228:231], v[48:63]
  ds_read_b128 a[252:255], v68 offset:39936
  v_exp_f32 v83, v83
  v_exp_f32 v84, v84
  v_exp_f32 v85, v85
  buffer_load_dwordx4 v4, s[36:39], s52 offen offset:2048 lds
  s_waitcnt lgkmcnt(4)
  v_mfma_f32_32x32x16_bf16 v[48:63], v[136:139], a[232:235], v[48:63]
  ds_read_b128 a[224:227], v69 offset:32768
  v_exp_f32 v86, v86
  v_exp_f32 v87, v87
  v_exp_f32 v88, v88
  buffer_load_dwordx4 v4, s[36:39], s53 offen offset:3072 lds
  v_mfma_f32_32x32x16_bf16 v[48:63], v[140:143], a[236:239], v[48:63]
  ds_read_b128 a[228:231], v69 offset:33792
  v_exp_f32 v89, v89
  v_exp_f32 v90, v90
  v_exp_f32 v91, v91
  s_add_u32 m0, s48, 69632
  v_add_u32 v4, 32768, v4
  buffer_load_dwordx4 v4, s[36:39], 0 offen lds
  s_waitcnt lgkmcnt(4)
  v_mfma_f32_32x32x16_bf16 v[48:63], v[144:147], a[240:243], v[48:63]
  ds_read_b128 a[232:235], v69 offset:34816
  v_exp_f32 v92, v92
  v_exp_f32 v93, v93
  v_exp_f32 v94, v94
  buffer_load_dwordx4 v4, s[36:39], s51 offen offset:1024 lds
  v_mfma_f32_32x32x16_bf16 v[48:63], v[148:151], a[244:247], v[48:63]
  ds_read_b128 a[236:239], v69 offset:35840
  v_exp_f32 v95, v95
  v_add_f32 v80, 1.0, v80
  v_add_f32 v81, 1.0, v81
  buffer_load_dwordx4 v4, s[36:39], s52 offen offset:2048 lds
  s_waitcnt lgkmcnt(4)
  v_mfma_f32_32x32x16_bf16 v[48:63], v[152:155], a[248:251], v[48:63]
  ds_read_b128 a[240:243], v69 offset:36864
  v_add_f32 v82, 1.0, v82
  v_add_f32 v83, 1.0, v83
  v_add_f32 v84, 1.0, v84
  buffer_load_dwordx4 v4, s[36:39], s53 offen offset:3072 lds
  s_mov_b32 s64, 32768
  s_cmp_eq_u32 s57, 4
  s_cselect_b32 s64, 4294541312, s64
  v_add_u32 v4, s64, v4
  v_mfma_f32_32x32x16_bf16 v[48:63], v[156:159], a[252:255], v[48:63]
  ds_read_b128 a[244:247], v69 offset:37888
  v_add_f32 v85, 1.0, v85
  v_add_f32 v86, 1.0, v86
  v_add_f32 v87, 1.0, v87
  s_add_u32 m0, s49, 106496
  s_nop 0
  buffer_load_dwordx4 v4, s[36:39], 0 offen lds
  s_waitcnt lgkmcnt(4)
  v_mfma_f32_32x32x16_bf16 v[48:63], v[160:163], a[224:227], v[48:63]
  ds_read_b128 a[248:251], v69 offset:38912
  v_add_f32 v88, 1.0, v88
  v_add_f32 v89, 1.0, v89
  v_add_f32 v90, 1.0, v90
  buffer_load_dwordx4 v4, s[36:39], s51 offen offset:1024 lds
  v_mfma_f32_32x32x16_bf16 v[48:63], v[164:167], a[228:231], v[48:63]
  ds_read_b128 a[252:255], v69 offset:39936
  v_add_f32 v91, 1.0, v91
  v_add_f32 v92, 1.0, v92
  buffer_load_dwordx4 v4, s[36:39], s52 offen offset:2048 lds
  s_waitcnt lgkmcnt(4)
  v_mfma_f32_32x32x16_bf16 v[48:63], v[168:171], a[232:235], v[48:63]
  ds_read_b128 a[224:227], v70 offset:32768
  v_add_f32 v93, 1.0, v93
  v_add_f32 v94, 1.0, v94
  buffer_load_dwordx4 v4, s[36:39], s53 offen offset:3072 lds
  v_mfma_f32_32x32x16_bf16 v[48:63], v[172:175], a[236:239], v[48:63]
  ds_read_b128 a[228:231], v70 offset:33792
  v_add_f32 v95, 1.0, v95
  v_rcp_f32 v80, v80
  s_add_u32 m0, s49, 110592
  v_add_u32 v4, 32768, v4
  buffer_load_dwordx4 v4, s[36:39], 0 offen lds
  s_waitcnt lgkmcnt(4)
  v_mfma_f32_32x32x16_bf16 v[48:63], v[176:179], a[240:243], v[48:63]
  ds_read_b128 a[232:235], v70 offset:34816
  v_rcp_f32 v81, v81
  v_rcp_f32 v82, v82
  buffer_load_dwordx4 v4, s[36:39], s51 offen offset:1024 lds
  v_mfma_f32_32x32x16_bf16 v[48:63], v[180:183], a[244:247], v[48:63]
  ds_read_b128 a[236:239], v70 offset:35840
  v_rcp_f32 v83, v83
  v_rcp_f32 v84, v84
  buffer_load_dwordx4 v4, s[36:39], s52 offen offset:2048 lds
  s_waitcnt lgkmcnt(4)
  v_mfma_f32_32x32x16_bf16 v[48:63], v[184:187], a[248:251], v[48:63]
  ds_read_b128 a[240:243], v70 offset:36864
  v_rcp_f32 v85, v85
  v_rcp_f32 v86, v86
  buffer_load_dwordx4 v4, s[36:39], s53 offen offset:3072 lds
  s_mov_b32 s64, 32768
  s_cmp_eq_u32 s57, 3
  s_cselect_b32 s64, 4294541312, s64
  v_add_u32 v4, s64, v4
  v_mfma_f32_32x32x16_bf16 v[48:63], v[188:191], a[252:255], v[48:63]
  ds_read_b128 a[244:247], v70 offset:37888
  v_rcp_f32 v87, v87
  v_rcp_f32 v88, v88
  s_waitcnt vmcnt(16)
  ds_read_b64_tr_b16 a[32:33], v120 offset:0
  ds_read_b64_tr_b16 a[34:35], v120 offset:1024
  s_waitcnt lgkmcnt(6)
  v_mfma_f32_32x32x16_bf16 v[48:63], v[192:195], a[224:227], v[48:63]
  ds_read_b128 a[248:251], v70 offset:38912
  v_rcp_f32 v89, v89
  v_rcp_f32 v90, v90
  v_mfma_f32_32x32x16_bf16 v[48:63], v[196:199], a[228:231], v[48:63]
  ds_read_b128 a[252:255], v70 offset:39936
  v_rcp_f32 v91, v91
  v_rcp_f32 v92, v92
  ds_read_b64_tr_b16 a[36:37], v121 offset:0
  ds_read_b64_tr_b16 a[38:39], v121 offset:1024
  s_waitcnt lgkmcnt(8)
  v_mfma_f32_32x32x16_bf16 v[48:63], v[200:203], a[232:235], v[48:63]
  ds_read_b128 a[224:227], v71 offset:32768
  v_rcp_f32 v93, v93
  v_rcp_f32 v94, v94
  ds_read_b64_tr_b16 a[40:41], v120 offset:2048
  ds_read_b64_tr_b16 a[42:43], v120 offset:3072
  v_mfma_f32_32x32x16_bf16 v[48:63], v[204:207], a[236:239], v[48:63]
  ds_read_b128 a[228:231], v71 offset:33792
  v_rcp_f32 v95, v95
  v_mul_f32 v80, v80, v32
  ds_read_b64_tr_b16 a[44:45], v121 offset:2048
  ds_read_b64_tr_b16 a[46:47], v121 offset:3072
  s_waitcnt lgkmcnt(12)
  v_mfma_f32_32x32x16_bf16 v[48:63], v[208:211], a[240:243], v[48:63]
  ds_read_b128 a[232:235], v71 offset:34816
  v_mul_f32 v81, v81, v33
  v_mul_f32 v82, v82, v34
  ds_read_b64_tr_b16 a[48:49], v120 offset:4096
  ds_read_b64_tr_b16 a[50:51], v120 offset:5120
  v_mfma_f32_32x32x16_bf16 v[48:63], v[212:215], a[244:247], v[48:63]
  ds_read_b128 a[236:239], v71 offset:35840
  v_mul_f32 v83, v83, v35
  v_mul_f32 v84, v84, v36
  ds_read_b64_tr_b16 a[52:53], v121 offset:4096
  ds_read_b64_tr_b16 a[54:55], v121 offset:5120
  s_waitcnt lgkmcnt(14)
  v_mfma_f32_32x32x16_bf16 v[48:63], v[216:219], a[248:251], v[48:63]
  ds_read_b128 a[240:243], v71 offset:36864
  v_mul_f32 v85, v85, v37
  v_mul_f32 v86, v86, v38
  ds_read_b64_tr_b16 a[56:57], v120 offset:6144
  ds_read_b64_tr_b16 a[58:59], v120 offset:7168
  v_mfma_f32_32x32x16_bf16 v[48:63], v[220:223], a[252:255], v[48:63]
  ds_read_b128 a[244:247], v71 offset:37888
  v_mul_f32 v87, v87, v39
  v_mul_f32 v88, v88, v40
  ds_read_b64_tr_b16 a[60:61], v121 offset:6144
  ds_read_b64_tr_b16 a[62:63], v121 offset:7168
  s_waitcnt lgkmcnt(14)
  v_mfma_f32_32x32x16_bf16 v[48:63], v[224:227], a[224:227], v[48:63]
  ds_read_b128 a[248:251], v71 offset:38912
  v_mul_f32 v89, v89, v41
  v_mul_f32 v90, v90, v42
  s_waitcnt lgkmcnt(1)
  s_add_u32 m0, s49, 98304
  s_nop 0
  buffer_load_dwordx4 v4, s[36:39], 0 offen lds
  v_mfma_f32_32x32x16_bf16 v[48:63], v[228:231], a[228:231], v[48:63]
  ds_read_b128 a[252:255], v71 offset:39936
  v_mul_f32 v91, v91, v43
  v_mul_f32 v92, v92, v44
  buffer_load_dwordx4 v4, s[36:39], s51 offen offset:1024 lds
  v_mfma_f32_32x32x16_bf16 v[48:63], v[232:235], a[232:235], v[48:63]
  v_mul_f32 v93, v93, v45
  v_mul_f32 v94, v94, v46
  buffer_load_dwordx4 v4, s[36:39], s52 offen offset:2048 lds
  v_mfma_f32_32x32x16_bf16 v[48:63], v[236:239], a[236:239], v[48:63]
  v_mul_f32 v95, v95, v47
  v_cvt_pk_bf16_f32 v96, v80, v81
  buffer_load_dwordx4 v4, s[36:39], s53 offen offset:3072 lds
  v_mfma_f32_32x32x16_bf16 v[48:63], v[240:243], a[240:243], v[48:63]
  v_cvt_pk_bf16_f32 v97, v82, v83
  v_cvt_pk_bf16_f32 v98, v84, v85
  s_add_u32 m0, s49, 102400
  v_add_u32 v4, 32768, v4
  buffer_load_dwordx4 v4, s[36:39], 0 offen lds
  v_mfma_f32_32x32x16_bf16 v[48:63], v[244:247], a[244:247], v[48:63]
  v_cvt_pk_bf16_f32 v99, v86, v87
  v_cvt_pk_bf16_f32 v100, v88, v89
  buffer_load_dwordx4 v4, s[36:39], s51 offen offset:1024 lds
  s_waitcnt lgkmcnt(0)
  v_mfma_f32_32x32x16_bf16 v[48:63], v[248:251], a[248:251], v[48:63]
  v_cvt_pk_bf16_f32 v101, v90, v91
  v_cvt_pk_bf16_f32 v102, v92, v93
  buffer_load_dwordx4 v4, s[36:39], s52 offen offset:2048 lds
  v_mfma_f32_32x32x16_bf16 v[48:63], v[252:255], a[252:255], v[48:63]
  v_cvt_pk_bf16_f32 v103, v94, v95
  s_cmp_eq_u32 s62, 1
  s_cbranch_scc0 L_slow_13
  buffer_store_dwordx4 v[96:99], v28, s[40:43], 0 offen
  buffer_store_dwordx4 v[100:103], v28, s[40:43], 0 offen offset:1024
L_back_14:
  buffer_load_dwordx4 v4, s[36:39], s53 offen offset:3072 lds
  s_mov_b32 s64, 32768
  s_cmp_eq_u32 s57, 2
  s_cselect_b32 s64, 4294541312, s64
  v_add_u32 v4, s64, v4
  s_mov_b32 s3, 114688
  s_nop 10
  v_pk_mul_f32 v[48:49], v[48:49], v[124:125] op_sel_hi:[1,0]
  v_pk_mul_f32 v[50:51], v[50:51], v[124:125] op_sel_hi:[1,0]
  v_pk_mul_f32 v[52:53], v[52:53], v[124:125] op_sel_hi:[1,0]
  v_pk_mul_f32 v[54:55], v[54:55], v[124:125] op_sel_hi:[1,0]
  v_pk_mul_f32 v[56:57], v[56:57], v[124:125] op_sel_hi:[1,0]
  v_pk_mul_f32 v[58:59], v[58:59], v[124:125] op_sel_hi:[1,0]
  v_pk_mul_f32 v[60:61], v[60:61], v[124:125] op_sel_hi:[1,0]
  v_pk_mul_f32 v[62:63], v[62:63], v[124:125] op_sel_hi:[1,0]
  v_pk_mul_f32 v[80:81], v[48:49], v[48:49]
  v_pk_mul_f32 v[82:83], v[50:51], v[50:51]
  v_pk_mul_f32 v[84:85], v[52:53], v[52:53]
  v_pk_mul_f32 v[86:87], v[54:55], v[54:55]
  v_pk_mul_f32 v[88:89], v[56:57], v[56:57]
  v_pk_mul_f32 v[90:91], v[58:59], v[58:59]
  v_pk_mul_f32 v[92:93], v[60:61], v[60:61]
  v_pk_mul_f32 v[94:95], v[62:63], v[62:63]
  s_waitcnt vmcnt(18)
  ds_read_b64_tr_b16 a[64:65], v18 offset:0
  ds_read_b64_tr_b16 a[66:67], v18 offset:1024
  v_pk_fma_f32 v[80:81], v[80:81], s[68:69], v[14:15] op_sel_hi:[1,1,0]
  v_pk_fma_f32 v[82:83], v[82:83], s[68:69], v[14:15] op_sel_hi:[1,1,0]
  v_pk_fma_f32 v[84:85], v[84:85], s[68:69], v[14:15] op_sel_hi:[1,1,0]
  v_pk_fma_f32 v[86:87], v[86:87], s[68:69], v[14:15] op_sel_hi:[1,1,0]
  v_pk_fma_f32 v[88:89], v[88:89], s[68:69], v[14:15] op_sel_hi:[1,1,0]
  v_pk_fma_f32 v[90:91], v[90:91], s[68:69], v[14:15] op_sel_hi:[1,1,0]
  v_pk_fma_f32 v[92:93], v[92:93], s[68:69], v[14:15] op_sel_hi:[1,1,0]
  v_pk_fma_f32 v[94:95], v[94:95], s[68:69], v[14:15] op_sel_hi:[1,1,0]
  ds_read_b64_tr_b16 a[68:69], v19 offset:0
  ds_read_b64_tr_b16 a[70:71], v19 offset:1024
  v_pk_mul_f32 v[80:81], v[80:81], v[48:49]
  v_pk_mul_f32 v[82:83], v[82:83], v[50:51]
  v_pk_mul_f32 v[84:85], v[84:85], v[52:53]
  v_pk_mul_f32 v[86:87], v[86:87], v[54:55]
  v_pk_mul_f32 v[88:89], v[88:89], v[56:57]
  v_pk_mul_f32 v[90:91], v[90:91], v[58:59]
  v_pk_mul_f32 v[92:93], v[92:93], v[60:61]
  v_pk_mul_f32 v[94:95], v[94:95], v[62:63]
  ds_read_b64_tr_b16 a[72:73], v18 offset:2048
  ds_read_b64_tr_b16 a[74:75], v18 offset:3072
  v_exp_f32 v80, v80
  v_exp_f32 v81, v81
  v_exp_f32 v82, v82
  v_exp_f32 v83, v83
  v_exp_f32 v84, v84
  v_exp_f32 v85, v85
  v_exp_f32 v86, v86
  v_exp_f32 v87, v87
  ds_read_b64_tr_b16 a[76:77], v19 offset:2048
  ds_read_b64_tr_b16 a[78:79], v19 offset:3072
  v_exp_f32 v88, v88
  v_exp_f32 v89, v89
  v_exp_f32 v90, v90
  v_exp_f32 v91, v91
  v_exp_f32 v92, v92
  v_exp_f32 v93, v93
  v_exp_f32 v94, v94
  v_exp_f32 v95, v95
  v_pk_add_f32 v[80:81], v[80:81], 1.0 op_sel_hi:[1,0]
  v_pk_add_f32 v[82:83], v[82:83], 1.0 op_sel_hi:[1,0]
  v_pk_add_f32 v[84:85], v[84:85], 1.0 op_sel_hi:[1,0]
  v_pk_add_f32 v[86:87], v[86:87], 1.0 op_sel_hi:[1,0]
  v_pk_add_f32 v[88:89], v[88:89], 1.0 op_sel_hi:[1,0]
  v_pk_add_f32 v[90:91], v[90:91], 1.0 op_sel_hi:[1,0]
  v_pk_add_f32 v[92:93], v[92:93], 1.0 op_sel_hi:[1,0]
  v_pk_add_f32 v[94:95], v[94:95], 1.0 op_sel_hi:[1,0]
  v_rcp_f32 v80, v80
  v_rcp_f32 v81, v81
  v_rcp_f32 v82, v82
  v_rcp_f32 v83, v83
  v_rcp_f32 v84, v84
  v_rcp_f32 v85, v85
  v_rcp_f32 v86, v86
  v_rcp_f32 v87, v87
  v_rcp_f32 v88, v88
  v_rcp_f32 v89, v89
  v_rcp_f32 v90, v90
  v_rcp_f32 v91, v91
  v_rcp_f32 v92, v92
  v_rcp_f32 v93, v93
  v_rcp_f32 v94, v94
  v_rcp_f32 v95, v95
  v_pk_mul_f32 v[80:81], v[80:81], v[48:49]
  v_pk_mul_f32 v[82:83], v[82:83], v[50:51]
  v_pk_mul_f32 v[84:85], v[84:85], v[52:53]
  v_pk_mul_f32 v[86:87], v[86:87], v[54:55]
  v_pk_mul_f32 v[88:89], v[88:89], v[56:57]
  v_pk_mul_f32 v[90:91], v[90:91], v[58:59]
  v_pk_mul_f32 v[92:93], v[92:93], v[60:61]
  v_pk_mul_f32 v[94:95], v[94:95], v[62:63]
  v_cvt_pk_bf16_f32 v104, v80, v81
  v_cvt_pk_bf16_f32 v105, v82, v83
  v_cvt_pk_bf16_f32 v106, v84, v85
  v_cvt_pk_bf16_f32 v107, v86, v87
  v_cvt_pk_bf16_f32 v108, v88, v89
  v_cvt_pk_bf16_f32 v109, v90, v91
  v_cvt_pk_bf16_f32 v110, v92, v93
  v_cvt_pk_bf16_f32 v111, v94, v95
  s_cmp_eq_u32 s62, 1
  s_cbranch_scc0 L_slow_15
  buffer_store_dwordx4 v[104:107], v28, s[40:43], s3 offen
  buffer_store_dwordx4 v[108:111], v28, s[40:43], s3 offen offset:1024
L_back_16:
  s_add_u32 s3, s72, 1048576
  v_add_u32 v24, s3, v3
  buffer_load_dwordx4 v[112:115], v24, s[40:43], 0 offen sc1
  s_waitcnt vmcnt(1)
  s_cmp_eq_u32 s62, 1
  s_cbranch_scc0 L_slow_17
  buffer_store_dword v127, v7, s[40:43], 0 offen
L_back_18:
  ds_read_b64_tr_b16 a[80:81], v18 offset:4096
  ds_read_b64_tr_b16 a[82:83], v18 offset:5120
  ds_read_b64_tr_b16 a[84:85], v19 offset:4096
  ds_read_b64_tr_b16 a[86:87], v19 offset:5120
  ds_read_b64_tr_b16 a[88:89], v18 offset:6144
  ds_read_b64_tr_b16 a[90:91], v18 offset:7168
  ds_read_b64_tr_b16 a[92:93], v19 offset:6144
  ds_read_b64_tr_b16 a[94:95], v19 offset:7168
  s_waitcnt lgkmcnt(0)
  s_add_u32 m0, s48, 65536
  s_nop 0
  buffer_load_dwordx4 v4, s[36:39], 0 offen lds
  buffer_load_dwordx4 v4, s[36:39], s51 offen offset:1024 lds
  buffer_load_dwordx4 v4, s[36:39], s52 offen offset:2048 lds
  buffer_load_dwordx4 v4, s[36:39], s53 offen offset:3072 lds
  s_add_u32 m0, s48, 69632
  v_add_u32 v4, 32768, v4
  buffer_load_dwordx4 v4, s[36:39], 0 offen lds
  buffer_load_dwordx4 v4, s[36:39], s51 offen offset:1024 lds
  buffer_load_dwordx4 v4, s[36:39], s52 offen offset:2048 lds
  buffer_load_dwordx4 v4, s[36:39], s53 offen offset:3072 lds
  s_mov_b32 s64, 32768
  s_cmp_eq_u32 s57, 1
  s_cselect_b32 s64, 4294541312, s64
  v_add_u32 v4, s64, v4
  ds_read_b64_tr_b16 a[96:97], v120 offset:8192
  ds_read_b64_tr_b16 a[98:99], v120 offset:9216
  ds_read_b64_tr_b16 a[100:101], v121 offset:8192
  ds_read_b64_tr_b16 a[102:103], v121 offset:9216
  ds_read_b64_tr_b16 a[104:105], v120 offset:10240
  ds_read_b64_tr_b16 a[106:107], v120 offset:11264
  ds_read_b64_tr_b16 a[108:109], v121 offset:10240
  ds_read_b64_tr_b16 a[110:111], v121 offset:11264
  ds_read_b64_tr_b16 a[112:113], v120 offset:12288
  ds_read_b64_tr_b16 a[114:115], v120 offset:13312
  ds_read_b64_tr_b16 a[116:117], v121 offset:12288
  ds_read_b64_tr_b16 a[118:119], v121 offset:13312
  ds_read_b64_tr_b16 a[120:121], v120 offset:14336
  ds_read_b64_tr_b16 a[122:123], v120 offset:15360
  ds_read_b64_tr_b16 a[124:125], v121 offset:14336
  ds_read_b64_tr_b16 a[126:127], v121 offset:15360
  s_waitcnt lgkmcnt(0)
  s_add_u32 m0, s49, 106496
  s_nop 0
  buffer_load_dwordx4 v4, s[36:39], 0 offen lds
  buffer_load_dwordx4 v4, s[36:39], s51 offen offset:1024 lds
  buffer_load_dwordx4 v4, s[36:39], s52 offen offset:2048 lds
  buffer_load_dwordx4 v4, s[36:39], s53 offen offset:3072 lds
  s_add_u32 m0, s49, 110592
  v_add_u32 v4, 32768, v4
  buffer_load_dwordx4 v4, s[36:39], 0 offen lds
  buffer_load_dwordx4 v4, s[36:39], s51 offen offset:1024 lds
  buffer_load_dwordx4 v4, s[36:39], s52 offen offset:2048 lds
  buffer_load_dwordx4 v4, s[36:39], s53 offen offset:3072 lds
  s_mov_b32 s64, 32768
  s_cmp_eq_u32 s57, 0
  s_cselect_b32 s64, 4294541312, s64
  v_add_u32 v4, s64, v4
  ds_read_b64_tr_b16 a[128:129], v120 offset:0
  ds_read_b64_tr_b16 a[130:131], v120 offset:1024
  ds_read_b64_tr_b16 a[132:133], v121 offset:0
  ds_read_b64_tr_b16 a[134:135], v121 offset:1024
  ds_read_b64_tr_b16 a[136:137], v120 offset:2048
  ds_read_b64_tr_b16 a[138:139], v120 offset:3072
  ds_read_b64_tr_b16 a[140:141], v121 offset:2048
  ds_read_b64_tr_b16 a[142:143], v121 offset:3072
  ds_read_b64_tr_b16 a[144:145], v120 offset:4096
  ds_read_b64_tr_b16 a[146:147], v120 offset:5120
  ds_read_b64_tr_b16 a[148:149], v121 offset:4096
  ds_read_b64_tr_b16 a[150:151], v121 offset:5120
  ds_read_b64_tr_b16 a[152:153], v120 offset:6144
  ds_read_b64_tr_b16 a[154:155], v120 offset:7168
  ds_read_b64_tr_b16 a[156:157], v121 offset:6144
  ds_read_b64_tr_b16 a[158:159], v121 offset:7168
  s_waitcnt vmcnt(8)
  ds_read_b64_tr_b16 a[160:161], v18 offset:0
  ds_read_b64_tr_b16 a[162:163], v18 offset:1024
  ds_read_b64_tr_b16 a[164:165], v19 offset:0
  ds_read_b64_tr_b16 a[166:167], v19 offset:1024
  ds_read_b64_tr_b16 a[168:169], v18 offset:2048
  ds_read_b64_tr_b16 a[170:171], v18 offset:3072
  ds_read_b64_tr_b16 a[172:173], v19 offset:2048
  ds_read_b64_tr_b16 a[174:175], v19 offset:3072
  ds_read_b64_tr_b16 a[176:177], v18 offset:4096
  ds_read_b64_tr_b16 a[178:179], v18 offset:5120
  ds_read_b64_tr_b16 a[180:181], v19 offset:4096
  ds_read_b64_tr_b16 a[182:183], v19 offset:5120
  ds_read_b64_tr_b16 a[184:185], v18 offset:6144
  ds_read_b64_tr_b16 a[186:187], v18 offset:7168
  ds_read_b64_tr_b16 a[188:189], v19 offset:6144
  ds_read_b64_tr_b16 a[190:191], v19 offset:7168
  s_waitcnt vmcnt(0)
  ds_read_b64_tr_b16 a[192:193], v120 offset:8192
  ds_read_b64_tr_b16 a[194:195], v120 offset:9216
  ds_read_b64_tr_b16 a[196:197], v121 offset:8192
  ds_read_b64_tr_b16 a[198:199], v121 offset:9216
  ds_read_b64_tr_b16 a[200:201], v120 offset:10240
  ds_read_b64_tr_b16 a[202:203], v120 offset:11264
  ds_read_b64_tr_b16 a[204:205], v121 offset:10240
  ds_read_b64_tr_b16 a[206:207], v121 offset:11264
  ds_read_b64_tr_b16 a[208:209], v120 offset:12288
  ds_read_b64_tr_b16 a[210:211], v120 offset:13312
  ds_read_b64_tr_b16 a[212:213], v121 offset:12288
  ds_read_b64_tr_b16 a[214:215], v121 offset:13312
  ds_read_b64_tr_b16 a[216:217], v120 offset:14336
  ds_read_b64_tr_b16 a[218:219], v120 offset:15360
  ds_read_b64_tr_b16 a[220:221], v121 offset:14336
  ds_read_b64_tr_b16 a[222:223], v121 offset:15360
L_join:
  s_mul_i32 s3, s7, 114688
  s_mul_i32 s14, s11, 28672
  s_add_u32 s3, s3, s14
  s_add_u32 s3, s3, 2097152
  v_add_u32 v25, s3, v3
  v_lshlrev_b32 v64, 16, v112
  v_and_b32 v65, 0xffff0000, v112
  v_lshlrev_b32 v66, 16, v113
  v_and_b32 v67, 0xffff0000, v113
  v_lshlrev_b32 v68, 16, v114
  v_and_b32 v69, 0xffff0000, v114
  v_lshlrev_b32 v70, 16, v115
  v_and_b32 v71, 0xffff0000, v115
  s_waitcnt lgkmcnt(0)
  s_lshl_b32 s3, s10, 8
  s_mul_i32 s14, s11, 56
  s_add_u32 s3, s3, s14
  s_add_u32 s3, s3, 7352320
  v_min_u32 v24, 13, v0
  v_lshl_add_u32 v24, v24, 2, s3
  buffer_load_dword v26, v24, s[40:43], 0 offen sc1
  s_waitcnt vmcnt(0)
  v_cmp_ne_u32 vcc, s12, v26
  s_mov_b32 s65, 0x8000
  s_nop 3
  s_cmp_eq_u64 vcc, 0
  s_cbranch_scc0 L_poll_19
L_polld_20:
  s_lshl_b32 s64, s57, 12
  buffer_load_dwordx4 v[128:131], v25, s[40:43], s64 offen sc1
  buffer_load_dwordx4 v[132:135], v25, s[40:43], s64 offen offset:1024 sc1
  buffer_load_dwordx4 v[136:139], v25, s[40:43], s64 offen offset:2048 sc1
  buffer_load_dwordx4 v[140:143], v25, s[40:43], s64 offen offset:3072 sc1
  s_add_u32 s64, s64, 4096
  s_cmp_eq_u32 s64, 28672
  s_cselect_b32 s64, 0, s64
  buffer_load_dwordx4 v[144:147], v25, s[40:43], s64 offen sc1
  buffer_load_dwordx4 v[148:151], v25, s[40:43], s64 offen offset:1024 sc1
  buffer_load_dwordx4 v[152:155], v25, s[40:43], s64 offen offset:2048 sc1
  buffer_load_dwordx4 v[156:159], v25, s[40:43], s64 offen offset:3072 sc1
  s_add_u32 s64, s64, 4096
  s_cmp_eq_u32 s64, 28672
  s_cselect_b32 s64, 0, s64
  buffer_load_dwordx4 v[160:163], v25, s[40:43], s64 offen sc1
  buffer_load_dwordx4 v[164:167], v25, s[40:43], s64 offen offset:1024 sc1
  v_xor_b32 v16, 8192, v13
  v_xor_b32 v17, 16384, v13
  v_xor_b32 v18, 24576, v13
  s_waitcnt vmcnt(9)
  v_mfma_f32_32x32x16_bf16 v[32:47], a[0:3], v[128:131], 0
  buffer_load_dwordx4 v[168:171], v25, s[40:43], s64 offen offset:2048 sc1
  v_mfma_f32_32x32x16_bf16 v[48:63], a[4:7], v[128:131], 0
  s_waitcnt vmcnt(9)
  v_mfma_f32_32x32x16_bf16 v[32:47], a[8:11], v[132:135], v[32:47]
  buffer_load_dwordx4 v[172:175], v25, s[40:43], s64 offen offset:3072 sc1
  v_mfma_f32_32x32x16_bf16 v[48:63], a[12:15], v[132:135], v[48:63]
  s_waitcnt vmcnt(9)
  v_mfma_f32_32x32x16_bf16 v[32:47], a[16:19], v[136:139], v[32:47]
  s_add_u32 s64, s64, 4096
  s_cmp_eq_u32 s64, 28672
  s_cselect_b32 s64, 0, s64
  buffer_load_dwordx4 v[176:179], v25, s[40:43], s64 offen sc1
  v_mfma_f32_32x32x16_bf16 v[48:63], a[20:23], v[136:139], v[48:63]
  s_waitcnt vmcnt(9)
  v_mfma_f32_32x32x16_bf16 v[32:47], a[24:27], v[140:143], v[32:47]
  buffer_load_dwordx4 v[180:183], v25, s[40:43], s64 offen offset:1024 sc1
  v_mfma_f32_32x32x16_bf16 v[48:63], a[28:31], v[140:143], v[48:63]
  s_waitcnt vmcnt(9)
  v_mfma_f32_32x32x16_bf16 v[32:47], a[32:35], v[144:147], v[32:47]
  buffer_load_dwordx4 v[184:187], v25, s[40:43], s64 offen offset:2048 sc1
  v_mfma_f32_32x32x16_bf16 v[48:63], a[36:39], v[144:147], v[48:63]
  s_waitcnt vmcnt(9)
  v_mfma_f32_32x32x16_bf16 v[32:47], a[40:43], v[148:151], v[32:47]
  buffer_load_dwordx4 v[188:191], v25, s[40:43], s64 offen offset:3072 sc1
  v_mfma_f32_32x32x16_bf16 v[48:63], a[44:47], v[148:151], v[48:63]
  s_waitcnt vmcnt(9)
  v_mfma_f32_32x32x16_bf16 v[32:47], a[48:51], v[152:155], v[32:47]
  s_add_u32 s64, s64, 4096
  s_cmp_eq_u32 s64, 28672
  s_cselect_b32 s64, 0, s64
  buffer_load_dwordx4 v[192:195], v25, s[40:43], s64 offen sc1
  v_mfma_f32_32x32x16_bf16 v[48:63], a[52:55], v[152:155], v[48:63]
  s_waitcnt vmcnt(9)
  v_mfma_f32_32x32x16_bf16 v[32:47], a[56:59], v[156:159], v[32:47]
  buffer_load_dwordx4 v[196:199], v25, s[40:43], s64 offen offset:1024 sc1
  v_mfma_f32_32x32x16_bf16 v[48:63], a[60:63], v[156:159], v[48:63]
  s_waitcnt vmcnt(9)
  v_mfma_f32_32x32x16_bf16 v[32:47], a[64:67], v[160:163], v[32:47]
  buffer_load_dwordx4 v[200:203], v25, s[40:43], s64 offen offset:2048 sc1
  v_mfma_f32_32x32x16_bf16 v[48:63], a[68:71], v[160:163], v[48:63]
  s_waitcnt vmcnt(9)
  v_mfma_f32_32x32x16_bf16 v[32:47], a[72:75], v[164:167], v[32:47]
  buffer_load_dwordx4 v[204:207], v25, s[40:43], s64 offen offset:3072 sc1
  v_mfma_f32_32x32x16_bf16 v[48:63], a[76:79], v[164:167], v[48:63]
  s_waitcnt vmcnt(9)
  v_mfma_f32_32x32x16_bf16 v[32:47], a[80:83], v[168:171], v[32:47]
  s_add_u32 s64, s64, 4096
  s_cmp_eq_u32 s64, 28672
  s_cselect_b32 s64, 0, s64
  buffer_load_dwordx4 v[208:211], v25, s[40:43], s64 offen sc1
  v_mfma_f32_32x32x16_bf16 v[48:63], a[84:87], v[168:171], v[48:63]
  s_waitcnt vmcnt(9)
  v_mfma_f32_32x32x16_bf16 v[32:47], a[88:91], v[172:175], v[32:47]
  buffer_load_dwordx4 v[212:215], v25, s[40:43], s64 offen offset:1024 sc1
  v_mfma_f32_32x32x16_bf16 v[48:63], a[92:95], v[172:175], v[48:63]
  s_waitcnt vmcnt(9)
  v_mfma_f32_32x32x16_bf16 v[32:47], a[96:99], v[176:179], v[32:47]
  buffer_load_dwordx4 v[216:219], v25, s[40:43], s64 offen offset:2048 sc1
  v_mfma_f32_32x32x16_bf16 v[48:63], a[100:103], v[176:179], v[48:63]
  s_waitcnt vmcnt(9)
  v_mfma_f32_32x32x16_bf16 v[32:47], a[104:107], v[180:183], v[32:47]
  buffer_load_dwordx4 v[220:223], v25, s[40:43], s64 offen offset:3072 sc1
  v_mfma_f32_32x32x16_bf16 v[48:63], a[108:111], v[180:183], v[48:63]
  s_waitcnt vmcnt(9)
  v_mfma_f32_32x32x16_bf16 v[32:47], a[112:115], v[184:187], v[32:47]
  s_add_u32 s64, s64, 4096
  s_cmp_eq_u32 s64, 28672
  s_cselect_b32 s64, 0, s64
  buffer_load_dwordx4 v[224:227], v25, s[40:43], s64 offen sc1
  v_mfma_f32_32x32x16_bf16 v[48:63], a[116:119], v[184:187], v[48:63]
  s_waitcnt vmcnt(9)
  v_mfma_f32_32x32x16_bf16 v[32:47], a[120:123], v[188:191], v[32:47]
  buffer_load_dwordx4 v[228:231], v25, s[40:43], s64 offen offset:1024 sc1
  v_mfma_f32_32x32x16_bf16 v[48:63], a[124:127], v[188:191], v[48:63]
  s_waitcnt vmcnt(9)
  v_mfma_f32_32x32x16_bf16 v[32:47], a[128:131], v[192:195], v[32:47]
  buffer_load_dwordx4 v[232:235], v25, s[40:43], s64 offen offset:2048 sc1
  v_mfma_f32_32x32x16_bf16 v[48:63], a[132:135], v[192:195], v[48:63]
  s_waitcnt vmcnt(9)
  v_mfma_f32_32x32x16_bf16 v[32:47], a[136:139], v[196:199], v[32:47]
  buffer_load_dwordx4 v[236:239], v25, s[40:43], s64 offen offset:3072 sc1
  v_mfma_f32_32x32x16_bf16 v[48:63], a[140:143], v[196:199], v[48:63]
  s_waitcnt vmcnt(9)
  v_mfma_f32_32x32x16_bf16 v[32:47], a[144:147], v[200:203], v[32:47]
  v_mfma_f32_32x32x16_bf16 v[48:63], a[148:151], v[200:203], v[48:63]
  s_waitcnt vmcnt(8)
  v_mfma_f32_32x32x16_bf16 v[32:47], a[152:155], v[204:207], v[32:47]
  v_mfma_f32_32x32x16_bf16 v[48:63], a[156:159], v[204:207], v[48:63]
  s_waitcnt vmcnt(7)
  v_mfma_f32_32x32x16_bf16 v[32:47], a[160:163], v[208:211], v[32:47]
  v_mfma_f32_32x32x16_bf16 v[48:63], a[164:167], v[208:211], v[48:63]
  s_waitcnt vmcnt(6)
  v_mfma_f32_32x32x16_bf16 v[32:47], a[168:171], v[212:215], v[32:47]
  v_mfma_f32_32x32x16_bf16 v[48:63], a[172:175], v[212:215], v[48:63]
  s_waitcnt vmcnt(5)
  v_mfma_f32_32x32x16_bf16 v[32:47], a[176:179], v[216:219], v[32:47]
  v_mfma_f32_32x32x16_bf16 v[48:63], a[180:183], v[216:219], v[48:63]
  s_waitcnt vmcnt(4)
  v_mfma_f32_32x32x16_bf16 v[32:47], a[184:187], v[220:223], v[32:47]
  v_mfma_f32_32x32x16_bf16 v[48:63], a[188:191], v[220:223], v[48:63]
  s_waitcnt vmcnt(3)
  v_mfma_f32_32x32x16_bf16 v[32:47], a[192:195], v[224:227], v[32:47]
  v_mfma_f32_32x32x16_bf16 v[48:63], a[196:199], v[224:227], v[48:63]
  s_waitcnt vmcnt(2)
  v_mfma_f32_32x32x16_bf16 v[32:47], a[200:203], v[228:231], v[32:47]
  v_mfma_f32_32x32x16_bf16 v[48:63], a[204:207], v[228:231], v[48:63]
  s_waitcnt vmcnt(1)
  v_mfma_f32_32x32x16_bf16 v[32:47], a[208:211], v[232:235], v[32:47]
  v_mfma_f32_32x32x16_bf16 v[48:63], a[212:215], v[232:235], v[48:63]
  s_waitcnt vmcnt(0)
  v_mfma_f32_32x32x16_bf16 v[32:47], a[216:219], v[236:239], v[32:47]
  v_mfma_f32_32x32x16_bf16 v[48:63], a[220:223], v[236:239], v[48:63]
  s_nop 11
  ds_write_b128 v13, v[40:43] offset:2048
  ds_write_b128 v13, v[44:47] offset:3072
  ds_write_b128 v13, v[48:51] offset:4096
  ds_write_b128 v13, v[52:55] offset:5120
  ds_write_b128 v13, v[56:59] offset:6144
  ds_write_b128 v13, v[60:63] offset:7168
  s_waitcnt lgkmcnt(0)
  s_barrier
  ds_read_b128 v[80:83], v16 offset:2048
  ds_read_b128 v[84:87], v16 offset:3072
  ds_read_b128 v[88:91], v17 offset:4096
  ds_read_b128 v[92:95], v17 offset:5120
  ds_read_b128 v[96:99], v18 offset:6144
  ds_read_b128 v[100:103], v18 offset:7168
  v_pk_add_f32 v[32:33], v[32:33], v[64:65]
  v_pk_add_f32 v[34:35], v[34:35], v[66:67]
  v_pk_add_f32 v[36:37], v[36:37], v[68:69]
  v_pk_add_f32 v[38:39], v[38:39], v[70:71]
  s_waitcnt lgkmcnt(4)
  v_pk_add_f32 v[32:33], v[32:33], v[80:81]
  v_pk_add_f32 v[34:35], v[34:35], v[82:83]
  v_pk_add_f32 v[36:37], v[36:37], v[84:85]
  v_pk_add_f32 v[38:39], v[38:39], v[86:87]
  s_waitcnt lgkmcnt(2)
  v_pk_add_f32 v[32:33], v[32:33], v[88:89]
  v_pk_add_f32 v[34:35], v[34:35], v[90:91]
  v_pk_add_f32 v[36:37], v[36:37], v[92:93]
  v_pk_add_f32 v[38:39], v[38:39], v[94:95]
  s_waitcnt lgkmcnt(0)
  v_pk_add_f32 v[32:33], v[32:33], v[96:97]
  v_pk_add_f32 v[34:35], v[34:35], v[98:99]
  v_pk_add_f32 v[36:37], v[36:37], v[100:101]
  v_pk_add_f32 v[38:39], v[38:39], v[102:103]
  v_cvt_pk_bf16_f32 v104, v32, v33
  v_cvt_pk_bf16_f32 v105, v34, v35
  v_cvt_pk_bf16_f32 v106, v36, v37
  v_cvt_pk_bf16_f32 v107, v38, v39
  buffer_store_dwordx2 v[104:105], v31, s[44:47], 0 offen
  buffer_store_dwordx2 v[106:107], v31, s[44:47], 0 offen offset:16
L_tail:
L_end:
  s_endpgm
L_idle:
  s_mul_i32 s67, s11, 40960
  s_add_u32 s3, s49, 98304
  s_sub_u32 s3, s67, s3
  v_add_u32 v18, s3, v120
  v_xor_b32 v19, 64, v18
  s_add_u32 m0, s67, 0
  s_nop 0
  buffer_load_dwordx4 v4, s[36:39], 0 offen lds
  buffer_load_dwordx4 v4, s[36:39], s51 offen offset:1024 lds
  buffer_load_dwordx4 v4, s[36:39], s52 offen offset:2048 lds
  buffer_load_dwordx4 v4, s[36:39], s53 offen offset:3072 lds
  s_add_u32 m0, s67, 4096
  v_add_u32 v4, 32768, v4
  buffer_load_dwordx4 v4, s[36:39], 0 offen lds
  buffer_load_dwordx4 v4, s[36:39], s51 offen offset:1024 lds
  buffer_load_dwordx4 v4, s[36:39], s52 offen offset:2048 lds
  buffer_load_dwordx4 v4, s[36:39], s53 offen offset:3072 lds
  s_mov_b32 s64, 32768
  s_cmp_eq_u32 s57, 6
  s_cselect_b32 s64, 4294541312, s64
  v_add_u32 v4, s64, v4
  s_add_u32 m0, s67, 8192
  s_nop 0
  buffer_load_dwordx4 v4, s[36:39], 0 offen lds
  buffer_load_dwordx4 v4, s[36:39], s51 offen offset:1024 lds
  buffer_load_dwordx4 v4, s[36:39], s52 offen offset:2048 lds
  buffer_load_dwordx4 v4, s[36:39], s53 offen offset:3072 lds
  s_add_u32 m0, s67, 12288
  v_add_u32 v4, 32768, v4
  buffer_load_dwordx4 v4, s[36:39], 0 offen lds
  buffer_load_dwordx4 v4, s[36:39], s51 offen offset:1024 lds
  buffer_load_dwordx4 v4, s[36:39], s52 offen offset:2048 lds
  buffer_load_dwordx4 v4, s[36:39], s53 offen offset:3072 lds
  s_mov_b32 s64, 32768
  s_cmp_eq_u32 s57, 5
  s_cselect_b32 s64, 4294541312, s64
  v_add_u32 v4, s64, v4
  s_add_u32 m0, s67, 16384
  s_nop 0
  buffer_load_dwordx4 v4, s[36:39], 0 offen lds
  buffer_load_dwordx4 v4, s[36:39], s51 offen offset:1024 lds
  buffer_load_dwordx4 v4, s[36:39], s52 offen offset:2048 lds
  buffer_load_dwordx4 v4, s[36:39], s53 offen offset:3072 lds
  s_add_u32 m0, s67, 20480
  v_add_u32 v4, 32768, v4
  buffer_load_dwordx4 v4, s[36:39], 0 offen lds
  buffer_load_dwordx4 v4, s[36:39], s51 offen offset:1024 lds
  buffer_load_dwordx4 v4, s[36:39], s52 offen offset:2048 lds
  buffer_load_dwordx4 v4, s[36:39], s53 offen offset:3072 lds
  s_mov_b32 s64, 32768
  s_cmp_eq_u32 s57, 4
  s_cselect_b32 s64, 4294541312, s64
  v_add_u32 v4, s64, v4
  s_add_u32 m0, s67, 24576
  s_nop 0
  buffer_load_dwordx4 v4, s[36:39], 0 offen lds
  buffer_load_dwordx4 v4, s[36:39], s51 offen offset:1024 lds
  buffer_load_dwordx4 v4, s[36:39], s52 offen offset:2048 lds
  buffer_load_dwordx4 v4, s[36:39], s53 offen offset:3072 lds
  s_add_u32 m0, s67, 28672
  v_add_u32 v4, 32768, v4
  buffer_load_dwordx4 v4, s[36:39], 0 offen lds
  buffer_load_dwordx4 v4, s[36:39], s51 offen offset:1024 lds
  buffer_load_dwordx4 v4, s[36:39], s52 offen offset:2048 lds
  buffer_load_dwordx4 v4, s[36:39], s53 offen offset:3072 lds
  s_mov_b32 s64, 32768
  s_cmp_eq_u32 s57, 3
  s_cselect_b32 s64, 4294541312, s64
  v_add_u32 v4, s64, v4
  s_add_u32 m0, s67, 32768
  s_nop 0
  buffer_load_dwordx4 v4, s[36:39], 0 offen lds
  buffer_load_dwordx4 v4, s[36:39], s51 offen offset:1024 lds
  buffer_load_dwordx4 v4, s[36:39], s52 offen offset:2048 lds
  buffer_load_dwordx4 v4, s[36:39], s53 offen offset:3072 lds
  s_add_u32 m0, s67, 36864
  v_add_u32 v4, 32768, v4
  buffer_load_dwordx4 v4, s[36:39], 0 offen lds
  buffer_load_dwordx4 v4, s[36:39], s51 offen offset:1024 lds
  buffer_load_dwordx4 v4, s[36:39], s52 offen offset:2048 lds
  buffer_load_dwordx4 v4, s[36:39], s53 offen offset:3072 lds
  s_mov_b32 s64, 32768
  s_cmp_eq_u32 s57, 2
  s_cselect_b32 s64, 4294541312, s64
  v_add_u32 v4, s64, v4
  s_waitcnt vmcnt(32)
  ds_read_b64_tr_b16 a[0:1], v18 offset:0
  ds_read_b64_tr_b16 a[2:3], v18 offset:1024
  ds_read_b64_tr_b16 a[4:5], v19 offset:0
  ds_read_b64_tr_b16 a[6:7], v19 offset:1024
  ds_read_b64_tr_b16 a[8:9], v18 offset:2048
  ds_read_b64_tr_b16 a[10:11], v18 offset:3072
  ds_read_b64_tr_b16 a[12:13], v19 offset:2048
  ds_read_b64_tr_b16 a[14:15], v19 offset:3072
  ds_read_b64_tr_b16 a[16:17], v18 offset:4096
  ds_read_b64_tr_b16 a[18:19], v18 offset:5120
  ds_read_b64_tr_b16 a[20:21], v19 offset:4096
  ds_read_b64_tr_b16 a[22:23], v19 offset:5120
  ds_read_b64_tr_b16 a[24:25], v18 offset:6144
  ds_read_b64_tr_b16 a[26:27], v18 offset:7168
  ds_read_b64_tr_b16 a[28:29], v19 offset:6144
  ds_read_b64_tr_b16 a[30:31], v19 offset:7168
  s_waitcnt vmcnt(24)
  ds_read_b64_tr_b16 a[32:33], v18 offset:8192
  ds_read_b64_tr_b16 a[34:35], v18 offset:9216
  ds_read_b64_tr_b16 a[36:37], v19 offset:8192
  ds_read_b64_tr_b16 a[38:39], v19 offset:9216
  ds_read_b64_tr_b16 a[40:41], v18 offset:10240
  ds_read_b64_tr_b16 a[42:43], v18 offset:11264
  ds_read_b64_tr_b16 a[44:45], v19 offset:10240
  ds_read_b64_tr_b16 a[46:47], v19 offset:11264
  ds_read_b64_tr_b16 a[48:49], v18 offset:12288
  ds_read_b64_tr_b16 a[50:51], v18 offset:13312
  ds_read_b64_tr_b16 a[52:53], v19 offset:12288
  ds_read_b64_tr_b16 a[54:55], v19 offset:13312
  ds_read_b64_tr_b16 a[56:57], v18 offset:14336
  ds_read_b64_tr_b16 a[58:59], v18 offset:15360
  ds_read_b64_tr_b16 a[60:61], v19 offset:14336
  ds_read_b64_tr_b16 a[62:63], v19 offset:15360
  s_waitcnt lgkmcnt(0)
  s_add_u32 m0, s67, 0
  s_nop 0
  buffer_load_dwordx4 v4, s[36:39], 0 offen lds
  buffer_load_dwordx4 v4, s[36:39], s51 offen offset:1024 lds
  buffer_load_dwordx4 v4, s[36:39], s52 offen offset:2048 lds
  buffer_load_dwordx4 v4, s[36:39], s53 offen offset:3072 lds
  s_add_u32 m0, s67, 4096
  v_add_u32 v4, 32768, v4
  buffer_load_dwordx4 v4, s[36:39], 0 offen lds
  buffer_load_dwordx4 v4, s[36:39], s51 offen offset:1024 lds
  buffer_load_dwordx4 v4, s[36:39], s52 offen offset:2048 lds
  buffer_load_dwordx4 v4, s[36:39], s53 offen offset:3072 lds
  s_mov_b32 s64, 32768
  s_cmp_eq_u32 s57, 1
  s_cselect_b32 s64, 4294541312, s64
  v_add_u32 v4, s64, v4
  s_add_u32 m0, s67, 8192
  s_nop 0
  buffer_load_dwordx4 v4, s[36:39], 0 offen lds
  buffer_load_dwordx4 v4, s[36:39], s51 offen offset:1024 lds
  buffer_load_dwordx4 v4, s[36:39], s52 offen offset:2048 lds
  buffer_load_dwordx4 v4, s[36:39], s53 offen offset:3072 lds
  s_add_u32 m0, s67, 12288
  v_add_u32 v4, 32768, v4
  buffer_load_dwordx4 v4, s[36:39], 0 offen lds
  buffer_load_dwordx4 v4, s[36:39], s51 offen offset:1024 lds
  buffer_load_dwordx4 v4, s[36:39], s52 offen offset:2048 lds
  buffer_load_dwordx4 v4, s[36:39], s53 offen offset:3072 lds
  s_mov_b32 s64, 32768
  s_cmp_eq_u32 s57, 0
  s_cselect_b32 s64, 4294541312, s64
  v_add_u32 v4, s64, v4
  s_add_u32 s3, s72, 1048576
  v_add_u32 v24, s3, v3
  buffer_load_dwordx4 v[112:115], v24, s[40:43], 0 offen sc1
  s_waitcnt vmcnt(33)
  ds_read_b64_tr_b16 a[64:65], v18 offset:16384
  ds_read_b64_tr_b16 a[66:67], v18 offset:17408
  ds_read_b64_tr_b16 a[68:69], v19 offset:16384
  ds_read_b64_tr_b16 a[70:71], v19 offset:17408
  ds_read_b64_tr_b16 a[72:73], v18 offset:18432
  ds_read_b64_tr_b16 a[74:75], v18 offset:19456
  ds_read_b64_tr_b16 a[76:77], v19 offset:18432
  ds_read_b64_tr_b16 a[78:79], v19 offset:19456
  ds_read_b64_tr_b16 a[80:81], v18 offset:20480
  ds_read_b64_tr_b16 a[82:83], v18 offset:21504
  ds_read_b64_tr_b16 a[84:85], v19 offset:20480
  ds_read_b64_tr_b16 a[86:87], v19 offset:21504
  ds_read_b64_tr_b16 a[88:89], v18 offset:22528
  ds_read_b64_tr_b16 a[90:91], v18 offset:23552
  ds_read_b64_tr_b16 a[92:93], v19 offset:22528
  ds_read_b64_tr_b16 a[94:95], v19 offset:23552
  s_waitcnt vmcnt(25)
  ds_read_b64_tr_b16 a[96:97], v18 offset:24576
  ds_read_b64_tr_b16 a[98:99], v18 offset:25600
  ds_read_b64_tr_b16 a[100:101], v19 offset:24576
  ds_read_b64_tr_b16 a[102:103], v19 offset:25600
  ds_read_b64_tr_b16 a[104:105], v18 offset:26624
  ds_read_b64_tr_b16 a[106:107], v18 offset:27648
  ds_read_b64_tr_b16 a[108:109], v19 offset:26624
  ds_read_b64_tr_b16 a[110:111], v19 offset:27648
  ds_read_b64_tr_b16 a[112:113], v18 offset:28672
  ds_read_b64_tr_b16 a[114:115], v18 offset:29696
  ds_read_b64_tr_b16 a[116:117], v19 offset:28672
  ds_read_b64_tr_b16 a[118:119], v19 offset:29696
  ds_read_b64_tr_b16 a[120:121], v18 offset:30720
  ds_read_b64_tr_b16 a[122:123], v18 offset:31744
  ds_read_b64_tr_b16 a[124:125], v19 offset:30720
  ds_read_b64_tr_b16 a[126:127], v19 offset:31744
  s_waitcnt vmcnt(17)
  ds_read_b64_tr_b16 a[128:129], v18 offset:32768
  ds_read_b64_tr_b16 a[130:131], v18 offset:33792
  ds_read_b64_tr_b16 a[132:133], v19 offset:32768
  ds_read_b64_tr_b16 a[134:135], v19 offset:33792
  ds_read_b64_tr_b16 a[136:137], v18 offset:34816
  ds_read_b64_tr_b16 a[138:139], v18 offset:35840
  ds_read_b64_tr_b16 a[140:141], v19 offset:34816
  ds_read_b64_tr_b16 a[142:143], v19 offset:35840
  ds_read_b64_tr_b16 a[144:145], v18 offset:36864
  ds_read_b64_tr_b16 a[146:147], v18 offset:37888
  ds_read_b64_tr_b16 a[148:149], v19 offset:36864
  ds_read_b64_tr_b16 a[150:151], v19 offset:37888
  ds_read_b64_tr_b16 a[152:153], v18 offset:38912
  ds_read_b64_tr_b16 a[154:155], v18 offset:39936
  ds_read_b64_tr_b16 a[156:157], v19 offset:38912
  ds_read_b64_tr_b16 a[158:159], v19 offset:39936
  s_waitcnt vmcnt(9)
  ds_read_b64_tr_b16 a[160:161], v18 offset:0
  ds_read_b64_tr_b16 a[162:163], v18 offset:1024
  ds_read_b64_tr_b16 a[164:165], v19 offset:0
  ds_read_b64_tr_b16 a[166:167], v19 offset:1024
  ds_read_b64_tr_b16 a[168:169], v18 offset:2048
  ds_read_b64_tr_b16 a[170:171], v18 offset:3072
  ds_read_b64_tr_b16 a[172:173], v19 offset:2048
  ds_read_b64_tr_b16 a[174:175], v19 offset:3072
  ds_read_b64_tr_b16 a[176:177], v18 offset:4096
  ds_read_b64_tr_b16 a[178:179], v18 offset:5120
  ds_read_b64_tr_b16 a[180:181], v19 offset:4096
  ds_read_b64_tr_b16 a[182:183], v19 offset:5120
  ds_read_b64_tr_b16 a[184:185], v18 offset:6144
  ds_read_b64_tr_b16 a[186:187], v18 offset:7168
  ds_read_b64_tr_b16 a[188:189], v19 offset:6144
  ds_read_b64_tr_b16 a[190:191], v19 offset:7168
  s_waitcnt vmcnt(1)
  ds_read_b64_tr_b16 a[192:193], v18 offset:8192
  ds_read_b64_tr_b16 a[194:195], v18 offset:9216
  ds_read_b64_tr_b16 a[196:197], v19 offset:8192
  ds_read_b64_tr_b16 a[198:199], v19 offset:9216
  ds_read_b64_tr_b16 a[200:201], v18 offset:10240
  ds_read_b64_tr_b16 a[202:203], v18 offset:11264
  ds_read_b64_tr_b16 a[204:205], v19 offset:10240
  ds_read_b64_tr_b16 a[206:207], v19 offset:11264
  ds_read_b64_tr_b16 a[208:209], v18 offset:12288
  ds_read_b64_tr_b16 a[210:211], v18 offset:13312
  ds_read_b64_tr_b16 a[212:213], v19 offset:12288
  ds_read_b64_tr_b16 a[214:215], v19 offset:13312
  ds_read_b64_tr_b16 a[216:217], v18 offset:14336
  ds_read_b64_tr_b16 a[218:219], v18 offset:15360
  ds_read_b64_tr_b16 a[220:221], v19 offset:14336
  ds_read_b64_tr_b16 a[222:223], v19 offset:15360
  s_waitcnt vmcnt(0) lgkmcnt(0)
  s_branch L_join
L_p1_1:
  s_mov_b32 s62, 0
  buffer_load_dword v26, v24, s[40:43], 0 offen sc1
  buffer_load_dwordx2 v[20:21], v27, s[40:43], 0 offen sc1
  s_sub_u32 s65, s65, 1
  s_cmp_eq_u32 s65, 0
  s_cbranch_scc1 L_p1d_2
  s_waitcnt vmcnt(0)
  v_cmp_ne_u32 vcc, s12, v20
  v_cmp_ne_u32 s[58:59], s12, v26
  s_nop 4
  s_cmp_eq_u64 vcc, 0
  s_cbranch_scc0 L_p1_1
  v_cmp_ne_u32 vcc, s63, v21
  s_nop 4
  s_cmp_eq_u64 vcc, 0
  s_cbranch_scc0 L_p1n_3
  s_cmp_eq_u64 s[58:59], 0
  s_cbranch_scc0 L_p1_1
  s_mov_b32 s62, 1
  s_branch L_p1d_2
L_p1n_3:
  buffer_store_dwordx2 v[60:61], v30, s[40:43], 0 offen sc1
  buffer_store_dwordx2 v[62:63], v30, s[40:43], 0 offen offset:256 sc1
  v_add_u32 v26, 4096, v8
  s_waitcnt vmcnt(0)
  buffer_store_dword v127, v26, s[40:43], 0 offen sc1
  v_add_u32 v24, 4096, v24
L_p1g_4:
  buffer_load_dword v26, v24, s[40:43], 0 offen sc1
  s_sub_u32 s65, s65, 1
  s_cmp_eq_u32 s65, 0
  s_cbranch_scc1 L_p1d_2
  s_waitcnt vmcnt(0)
  v_cmp_ne_u32 vcc, s12, v26
  s_nop 4
  s_cmp_eq_u64 vcc, 0
  s_cbranch_scc0 L_p1g_4
  s_branch L_p1d_2
L_slow_5:
  buffer_store_dwordx2 v[112:113], v24, s[40:43], 0 offen sc1
  buffer_store_dwordx2 v[114:115], v24, s[40:43], 0 offen offset:256 sc1
  s_branch L_back_6
L_slow_7:
  buffer_store_dwordx2 v[20:21], v5, s[40:43], 0 offen sc1
  buffer_store_dwordx2 v[22:23], v5, s[40:43], 0 offen offset:128 sc1
  s_branch L_back_8
L_slow_9:
  buffer_store_dword v127, v6, s[40:43], 0 offen sc1
  s_branch L_back_10
L_poll_11:
  buffer_load_dword v26, v24, s[40:43], 0 offen sc1
  s_sub_u32 s65, s65, 1
  s_cmp_eq_u32 s65, 0
  s_cbranch_scc1 L_polld_12
  s_waitcnt vmcnt(0)
  v_cmp_ne_u32 vcc, s12, v26
  s_nop 4
  s_cmp_eq_u64 vcc, 0
  s_cbranch_scc0 L_poll_11
  s_branch L_polld_12
L_slow_13:
  buffer_store_dwordx4 v[96:99], v28, s[40:43], 0 offen sc1
  buffer_store_dwordx4 v[100:103], v28, s[40:43], 0 offen offset:1024 sc1
  s_branch L_back_14
L_slow_15:
  buffer_store_dwordx4 v[104:107], v28, s[40:43], s3 offen sc1
  buffer_store_dwordx4 v[108:111], v28, s[40:43], s3 offen offset:1024 sc1
  s_branch L_back_16
L_slow_17:
  buffer_store_dword v127, v7, s[40:43], 0 offen sc1
  s_branch L_back_18
L_poll_19:
  buffer_load_dword v26, v24, s[40:43], 0 offen sc1
  s_sub_u32 s65, s65, 1
  s_cmp_eq_u32 s65, 0
  s_cbranch_scc1 L_polld_20
  s_waitcnt vmcnt(0)
  v_cmp_ne_u32 vcc, s12, v26
  s_nop 4
  s_cmp_eq_u64 vcc, 0
  s_cbranch_scc0 L_poll_19
  s_branch L_polld_20
L_code_end:
  s_endpgm
.section .rodata,"a"
.p2align 6
.amdhsa_kernel standalone__mixer_s_mlp__sampling_kernel
  .amdhsa_next_free_vgpr 512
  .amdhsa_next_free_sgpr 102
  .amdhsa_accum_offset 256
  .amdhsa_group_segment_fixed_size 0
  .amdhsa_kernarg_size 64
  .amdhsa_user_sgpr_count 2
  .amdhsa_user_sgpr_kernarg_segment_ptr 1
  .amdhsa_system_sgpr_workgroup_id_x 1
  .amdhsa_float_denorm_mode_32 3
.end_amdhsa_kernel
```
